```python
import torch

def _softmax(x, axis=-1):
    return torch.softmax(x, dim=axis)
def _gelu(x):
    return torch.nn.functional.gelu(x, approximate="tanh")
def _silu(x):
    return torch.nn.functional.silu(x)
def _sigmoid(x):
    return torch.sigmoid(x)
def _layernorm(x, axis=-1, eps=1e-5):
    m = x.mean(dim=axis, keepdim=True)
    v = x.var(dim=axis, keepdim=True, unbiased=False)
    return (x - m) / torch.sqrt(v + eps)
def _scatter_add(tgt, idx, src, axis=0):
    return tgt.clone().index_add_(axis, idx, src)
def _segment_sum(src, seg, n):
    out = torch.zeros((n,) + src.shape[1:], dtype=src.dtype)
    return out.index_add_(0, seg, src)
def _pad(x, pw):
    flat = tuple(v for pair in reversed(pw) for v in pair)
    return torch.nn.functional.pad(x, flat)

kernel_name = 'parallel_sum__sliding_local_dilated__mixer_s_mlp__prompt'

def setup_inputs():

    _w = (lambda a: (lambda t: t.to(torch.bfloat16) if t.is_floating_point() else t)(torch.as_tensor(a)))
    def _A_setup():
        B, S, D = 1, 2048, 512
        return {
            "x": _w((lambda *s: torch.randn(*s, dtype=torch.bfloat16) * 0.05)(B, S, D)),
            "wqkv": _w((lambda *s: torch.randn(*s, dtype=torch.bfloat16) * 0.05)(D, 3 * D)),
            "wo": _w((lambda *s: torch.randn(*s, dtype=torch.bfloat16) * 0.05)(D, D)),
        }
    _A_in = _A_setup()

    def _B_setup():
        B, S, D, F = 1, 2048, 512, 1376
        return {
            "x":  _w((lambda *s: torch.randn(*s, dtype=torch.bfloat16) * 0.05)(B, S, D)),
            "w1": _w((lambda *s: torch.randn(*s, dtype=torch.bfloat16) * 0.8)(D, D) * (D ** -0.5)),
            "w2": _w((lambda *s: torch.randn(*s, dtype=torch.bfloat16) * 0.8)(D, D) * (D ** -0.5)),
            "w3": _w((lambda *s: torch.randn(*s, dtype=torch.bfloat16) * 0.8)(D, F) * (D ** -0.5)),
            "w4": _w((lambda *s: torch.randn(*s, dtype=torch.bfloat16) * 0.8)(F, D) * (F ** -0.5)),
        }
    _B_in = _B_setup()

    return {
        "A_x": _A_in["x"],
        "A_wqkv": _A_in["wqkv"],
        "A_wo": _A_in["wo"],
        "B_x": _B_in["x"],
        "B_w1": _B_in["w1"],
        "B_w2": _B_in["w2"],
        "B_w3": _B_in["w3"],
        "B_w4": _B_in["w4"],
    }

def reference(A_x, A_wqkv, A_wo, B_x, B_w1, B_w2, B_w3, B_w4):
    def _A_ref(x, wqkv, wo):
        B, S, D = x.shape
        H = 32; Dh = D // H
        W, dil = 8, 2
        qkv = (lambda x, *d: x.permute(*d))((x @ wqkv).reshape(B, S, 3, H, Dh), 2, 0, 3, 1, 4)
        q, k, v = qkv[0], qkv[1], qkv[2]
        scale = Dh ** -0.5
        pos = torch.arange(S)
        off = torch.arange(W) * dil
        idx = pos[:, None] - off[None, :]
        mask = idx >= 0
        idx_c = torch.where(mask, idx, 0).reshape(-1)
        kg = k[:, :, idx_c, :].reshape(B, H, S, W, Dh)
        vg = v[:, :, idx_c, :].reshape(B, H, S, W, Dh)
        logits = torch.einsum("bhsd,bhswd->bhsw", q, kg) * scale
        logits = torch.where(mask[None, None, :, :], logits, -1e9)
        attn = _softmax(logits, axis=-1)
        o = torch.einsum("bhsw,bhswd->bhsd", attn, vg)
        return (lambda x, *d: x.permute(*d))(o, 0, 2, 1, 3).reshape(B, S, D) @ wo

    def _B_ref(x, w1, w2, w3, w4):
        B, S, D = x.shape
        h = _gelu(_layernorm(x, axis=-1) @ w1)
        c = D // 4
        g0 = _pad(h[:, :, 0*c:1*c], ((0, 0), (1, 0), (0, 0)))[:, :S, :]
        g1 = _pad(h[:, :, 1*c:2*c], ((0, 0), (0, 1), (0, 0)))[:, 1:, :]
        g2 = _pad(h[:, :, 2*c:3*c], ((0, 0), (2, 0), (0, 0)))[:, :S, :]
        g3 = _pad(h[:, :, 3*c:   ], ((0, 0), (0, 2), (0, 0)))[:, 2:, :]
        hs = torch.concatenate([g0, g1, g2, g3], axis=-1) @ w2
        x1 = x + hs
        h2 = _gelu(_layernorm(x1, axis=-1) @ w3) @ w4
        return x1 + h2

    x = A_x
    xn = _layernorm(x, axis=-1)
    return x + _A_ref(xn, A_wqkv, A_wo) + _B_ref(xn, B_w1, B_w2, B_w3, B_w4)
```

```asm
; @launch grid=(256,1,1) block=(256,1,1) lds=163840
.amdgcn_target "amdgcn-amd-amdhsa--gfx950"
.text
.globl parallel_sum__sliding_local_dilated__mixer_s_mlp__prompt_kernel
.p2align 8
.type parallel_sum__sliding_local_dilated__mixer_s_mlp__prompt_kernel,@function
parallel_sum__sliding_local_dilated__mixer_s_mlp__prompt_kernel:
    s_cmp_ge_u32 s2, 256
    s_cbranch_scc1 L_end
    s_load_dwordx16 s[16:31], s[0:1], 0
    s_load_dwordx4 s[32:35], s[0:1], 64
    s_load_dwordx2 s[36:37], s[0:1], 80
    s_getpc_b64 s[96:97]
    v_lshlrev_b32 v6, 7, v0
    v_cmp_gt_u32 vcc, 48, v0
    s_and_saveexec_b64 s[94:95], vcc
    s_cbranch_execz L_c0_1
    global_load_dword v255, v6, s[96:97]
L_c0_1:
    s_mov_b64 exec, s[94:95]
    v_lshrrev_b32 v5, 6, v0
    v_and_b32 v1, 63, v0
    v_readfirstlane_b32 s3, v5
    v_and_b32 v2, 31, v1
    v_lshrrev_b32 v3, 5, v1
    v_lshlrev_b32 v4, 4, v1
    s_and_b32 s10, s2, 7
    s_lshr_b32 s11, s2, 3
    s_lshr_b32 s86, s10, 1
    s_and_b32 s87, s10, 1
    s_lshr_b32 s85, s11, 2
    s_lshl_b32 s6, s86, 3
    s_add_u32 s6, s6, s85
    s_and_b32 s7, s11, 3
    s_lshl_b32 s85, s87, 2
    s_add_u32 s7, s7, s85
    s_lshr_b32 s85, s11, 3
    s_lshl_b32 s8, s86, 2
    s_add_u32 s8, s8, s85
    s_and_b32 s9, s11, 7
    s_lshl_b32 s85, s87, 3
    s_add_u32 s9, s9, s85
    s_and_b32 s4, s3, 1
    s_lshr_b32 s5, s3, 1
    s_and_b32 s14, s6, 3
    s_lshl_b32 s14, s14, 1
    s_add_u32 s14, s14, s7
    s_and_b32 s14, s14, 7
    s_lshl_b32 s15, s14, 1
    s_add_u32 s15, s15, s3
    s_lshl_b32 s15, s15, 2
    s_lshl_b32 s12, s3, 12
    s_lshr_b32 s88, s2, 3
    v_lshrrev_b32 v7, 3, v1
    v_and_b32 v8, 7, v1
    v_bfe_u32 v9, v1, 4, 1
    v_lshlrev_b32 v9, 2, v9
    v_xor_b32 v9, v8, v9
    v_lshlrev_b32 v9, 4, v9
    v_lshl_add_u32 v5, v7, 10, v9
    v_mul_u32_u24 v6, 3072, v7
    v_add_u32 v6, v6, v9
    v_lshrrev_b32 v9, 4, v1
    v_xor_b32 v9, v8, v9
    v_lshlrev_b32 v9, 4, v9
    v_lshl_add_u32 v14, v7, 10, v9
    v_xor_b32 v179, 64, v14
    v_add_u32 v179, 7168, v179
    v_add_u32 v136, 7168, v5
    s_waitcnt lgkmcnt(0)
    s_mov_b32 s40, s16
    s_and_b32 s41, s17, 0xffff
    s_mov_b32 s42, 2097152
    s_mov_b32 s43, 0x20000
    s_mov_b32 s52, s24
    s_and_b32 s53, s25, 0xffff
    s_mov_b32 s54, 524288
    s_mov_b32 s55, 0x20000
    s_mov_b32 s44, s18
    s_and_b32 s45, s19, 0xffff
    s_mov_b32 s46, 1572864
    s_mov_b32 s47, 0x20000
    s_lshl_b32 s10, s6, 16
    s_lshl_b32 s85, s3, 14
    s_add_u32 s10, s10, s85
    s_lshl_b32 s11, s7, 7
    s_add_u32 s11, s11, s85
    s_lshl_b32 s38, s3, 11
    s_add_u32 s92, s14, 0
    s_and_b32 s92, s92, 7
    s_lshl_b32 s39, s92, 7
    s_add_u32 m0, s38, 0
    s_add_u32 s39, s39, s10
    buffer_load_dwordx4 v14, s[40:43], s39 offen lds
    buffer_load_dwordx4 v179, s[40:43], s39 offen offset:1024 lds
    s_lshl_b32 s39, s92, 16
    s_add_u32 m0, s38, 67584
    s_add_u32 s39, s39, s11
    buffer_load_dwordx4 v5, s[52:55], s39 offen lds
    buffer_load_dwordx4 v136, s[52:55], s39 offen offset:1024 lds
    s_add_u32 s92, s14, 1
    s_and_b32 s92, s92, 7
    s_lshl_b32 s39, s92, 7
    s_add_u32 m0, s38, 8192
    s_add_u32 s39, s39, s10
    buffer_load_dwordx4 v14, s[40:43], s39 offen lds
    buffer_load_dwordx4 v179, s[40:43], s39 offen offset:1024 lds
    s_lshl_b32 s39, s92, 16
    s_add_u32 m0, s38, 75776
    s_add_u32 s39, s39, s11
    buffer_load_dwordx4 v5, s[52:55], s39 offen lds
    buffer_load_dwordx4 v136, s[52:55], s39 offen offset:1024 lds
    s_cmp_eq_u32 s3, 3
    s_cbranch_scc0 L_te_2
    s_mov_b64 s[94:95], exec
    s_mov_b64 exec, 0xff
    s_getpc_b64 s[96:97]
L_pc:
    s_lshl_b32 s85, s88, 10
    v_lshlrev_b32 v250, 7, v1
    v_add_u32 v250, s85, v250
    v_min_u32 v250, L_end-L_pc, v250
    global_load_dword v255, v250, s[96:97]
    s_bfm_b64 exec, 48, 0
    s_mul_i32 s85, s2, 6144
    v_lshlrev_b32 v250, 7, v1
    buffer_load_dword v255, v250, s[44:47], s85 offen
    s_mov_b64 exec, s[94:95]
L_te_2:
    s_mov_b32 s72, s36
    s_and_b32 s73, s37, 0xffff
    s_mov_b32 s74, 17825792
    s_mov_b32 s75, 0x20000
    s_mov_b32 s76, s34
    s_and_b32 s77, s35, 0xffff
    s_mov_b32 s78, 256
    s_mov_b32 s79, 0x20000
    s_mov_b32 s48, s20
    s_and_b32 s49, s21, 0xffff
    s_mov_b32 s50, 524288
    s_mov_b32 s51, 0x20000
    s_mov_b32 s56, s26
    s_and_b32 s57, s27, 0xffff
    s_mov_b32 s58, 524288
    s_mov_b32 s59, 0x20000
    s_mov_b32 s60, s28
    s_and_b32 s61, s29, 0xffff
    s_mov_b32 s62, 1409024
    s_mov_b32 s63, 0x20000
    s_mov_b32 s64, s30
    s_and_b32 s65, s31, 0xffff
    s_mov_b32 s66, 1409024
    s_mov_b32 s67, 0x20000
    s_mov_b32 s68, s32
    s_and_b32 s69, s33, 0xffff
    s_mov_b32 s70, 2097152
    s_mov_b32 s71, 0x20000
    s_lshr_b32 s19, s6, 2
    s_lshl_b32 s19, s19, 21
    s_and_b32 s20, s6, 3
    s_lshl_b32 s20, s20, 1
    s_add_u32 s20, s20, s4
    s_and_b32 s21, s8, 1
    s_lshl_b32 s21, s21, 2
    s_add_u32 s21, s21, s3
    s_cmp_lg_u32 s2, 0
    s_cbranch_scc1 L_zi_3
    s_cmp_lg_u32 s3, 3
    s_cbranch_scc1 L_zi_3
    v_lshrrev_b32 v250, 5, v1
    v_lshlrev_b32 v250, 21, v250
    v_and_b32 v251, 31, v1
    v_lshl_add_u32 v250, v251, 8, v250
    v_add_u32 v250, 1703936, v250
    v_mov_b32 v251, 0
    buffer_store_dword v251, v250, s[72:75], 0 offen sc1
    v_add_u32 v250, 4194304, v250
    buffer_store_dword v251, v250, s[72:75], 0 offen sc1
    v_add_u32 v250, 4194304, v250
    buffer_store_dword v251, v250, s[72:75], 0 offen sc1
    v_add_u32 v250, 4194304, v250
    buffer_store_dword v251, v250, s[72:75], 0 offen sc1
L_zi_3:
    v_mov_b32 v246, 0
    v_mov_b32 v250, 0
    s_mov_b32 s80, 0x3f803f80
    s_mov_b32 s81, 0x05040100
    s_mov_b32 s82, 0x07060302
    s_mov_b32 s85, s9
    s_cmp_eq_u32 s9, 3
    s_cselect_b32 s85, 11, s85
    s_cmp_eq_u32 s9, 11
    s_cselect_b32 s85, 3, s85
    s_cmp_eq_u32 s9, 7
    s_cselect_b32 s85, 12, s85
    s_cmp_eq_u32 s9, 12
    s_cselect_b32 s85, 7, s85
    s_mov_b32 s9, s85
    s_mul_i32 s89, s9, 3
    s_mov_b32 s90, 3
    s_cmp_lt_u32 s9, 11
    s_cbranch_scc1 L_ft_4
    s_lshl_b32 s89, s9, 1
    s_add_u32 s89, s89, 11
    s_mov_b32 s90, 2
L_ft_4:
    s_lshl_b32 s27, s7, 7
    s_lshl_b32 s85, s3, 15
    s_add_u32 s27, s27, s85
    s_lshl_b32 s86, s7, 7
    s_mul_i32 s85, s3, 98304
    s_add_u32 s33, s85, s86
    s_lshl_b32 s85, s3, 16
    s_add_u32 s34, s85, s86
    s_mul_i32 s32, s3, 3072
    s_mov_b32 s30, 0
    s_mov_b32 s37, 0
    v_add_u32 v137, 14336, v5
    v_add_u32 v138, 21504, v5
    v_add_u32 v139, 702464, v5
    v_add_u32 v140, 709632, v5
    v_add_u32 v141, 23552, v6
    v_add_u32 v142, 47104, v6
    v_add_u32 v143, 70656, v6
    v_bfe_u32 v192, v1, 2, 2
    v_and_b32 v193, 3, v1
    v_lshlrev_b32 v193, 3, v193
    v_bfe_u32 v194, v1, 4, 1
    v_lshl_add_u32 v193, v194, 5, v193
    v_lshrrev_b32 v194, 1, v192
    v_xor_b32 v195, s5, v194
    v_lshlrev_b32 v195, 6, v195
    v_lshl_add_u32 v196, v192, 7, v193
    v_add_u32 v196, v196, v195
    v_lshl_add_u32 v10, v3, 10, v196
    v_lshl_add_u32 v11, v3, 9, v196
    v_xor_b32 v12, 64, v11
    v_mul_u32_u24 v197, 192, v192
    v_add_u32 v197, v197, v193
    v_mul_u32_u24 v198, 768, v3
    v_add_u32 v13, v197, v198
    s_mov_b32 s85, 43691
    s_movk_i32 s86, 2752
    v_add_u32 v192, 0, v1
    v_mul_u32_u24 v193, s85, v192
    v_lshrrev_b32 v193, 19, v193
    v_mul_u32_u24 v194, 12, v193
    v_sub_u32 v194, v192, v194
    v_mul_u32_u24 v193, s86, v193
    v_lshl_add_u32 v7, v194, 4, v193
    v_add_u32 v192, 64, v1
    v_mul_u32_u24 v193, s85, v192
    v_lshrrev_b32 v193, 19, v193
    v_mul_u32_u24 v194, 12, v193
    v_sub_u32 v194, v192, v194
    v_mul_u32_u24 v193, s86, v193
    v_lshl_add_u32 v8, v194, 4, v193
    v_subrev_u32 v8, 1024, v8
    v_add_u32 v192, 128, v1
    v_mul_u32_u24 v193, s85, v192
    v_lshrrev_b32 v193, 19, v193
    v_mul_u32_u24 v194, 12, v193
    v_sub_u32 v194, v192, v194
    v_mul_u32_u24 v193, s86, v193
    v_lshl_add_u32 v9, v194, 4, v193
    v_subrev_u32 v9, 2048, v9
    s_add_u32 s92, s14, 2
    s_and_b32 s92, s92, 7
    s_lshl_b32 s39, s92, 7
    s_add_u32 m0, s38, 16384
    s_add_u32 s39, s39, s10
    buffer_load_dwordx4 v14, s[40:43], s39 offen lds
    buffer_load_dwordx4 v179, s[40:43], s39 offen offset:1024 lds
    s_lshl_b32 s39, s92, 16
    s_add_u32 m0, s38, 83968
    s_add_u32 s39, s39, s11
    buffer_load_dwordx4 v5, s[52:55], s39 offen lds
    buffer_load_dwordx4 v136, s[52:55], s39 offen offset:1024 lds
    s_lshl_b32 s85, s4, 5
    v_add_u32 v198, s85, v2
    v_bfe_u32 v199, v198, 1, 3
    v_xor_b32 v199, v199, v3
    v_lshlrev_b32 v199, 4, v199
    v_lshl_add_u32 v192, v198, 7, v199
    v_xor_b32 v193, 32, v192
    v_xor_b32 v194, 64, v192
    v_xor_b32 v195, 96, v192
    s_lshl_b32 s85, s5, 6
    v_xor_b32 v196, s85, v192
    v_xor_b32 v197, 32, v196
    v_bfe_u32 v199, v198, 1, 3
    s_lshl_b32 s85, s5, 2
    v_xor_b32 v199, s85, v199
    v_lshlrev_b32 v199, 4, v199
    v_lshl_add_u32 v199, v198, 7, v199
    v_lshl_add_u32 v199, v3, 3, v199
    s_sub_u32 s26, s7, s14
    s_and_b32 s26, s26, 7
    s_lshl_b32 s85, s26, 13
    v_add_u32 v200, s85, v199
    v_add_u32 v201, 67584, v10
    v_mov_b32 v202, 0
    v_mov_b32 v203, 0
    v_mov_b32 v204, 0
    v_mov_b32 v205, 0
    v_mov_b32 v206, 0
    v_mov_b32 v207, 0
    s_waitcnt vmcnt(8)
    s_waitcnt lgkmcnt(0)
    s_barrier
    s_cmp_lg_u32 s26, 0
    s_cbranch_scc1 L_xr_5
    v_xor_b32 v224, 0, v200
    ds_read_b64 v[16:17], v224
    v_xor_b32 v224, 16, v200
    ds_read_b64 v[18:19], v224
    v_xor_b32 v224, 32, v200
    ds_read_b64 v[20:21], v224
    v_xor_b32 v224, 48, v200
    ds_read_b64 v[22:23], v224
L_xr_5:
    ds_read_b128 a[0:3], v192 offset:0
    ds_read_b64_tr_b16 v[64:65], v201 offset:0
    ds_read_b64_tr_b16 v[66:67], v201 offset:512
    ds_read_b128 v[208:211], v196 offset:0
    ds_read_b128 a[4:7], v193 offset:0
    ds_read_b64_tr_b16 v[68:69], v201 offset:2048
    ds_read_b64_tr_b16 v[70:71], v201 offset:2560
    ds_read_b128 v[212:215], v197 offset:0
    ds_read_b128 a[8:11], v194 offset:0
    ds_read_b64_tr_b16 v[72:73], v201 offset:4096
    ds_read_b64_tr_b16 v[74:75], v201 offset:4608
    ds_read_b128 a[12:15], v195 offset:0
    ds_read_b64_tr_b16 v[76:77], v201 offset:6144
    ds_read_b64_tr_b16 v[78:79], v201 offset:6656
    s_waitcnt vmcnt(4)
    s_waitcnt lgkmcnt(0)
    s_barrier
    v_mfma_f32_32x32x16_bf16 v[144:159], v[64:67], a[0:3], 0
    ds_read_b128 a[16:19], v192 offset:8192
    ds_read_b64_tr_b16 v[80:81], v201 offset:8192
    ds_read_b64_tr_b16 v[82:83], v201 offset:8704
    ds_read_b128 v[216:219], v196 offset:8192
    s_add_u32 s92, s14, 3
    s_and_b32 s92, s92, 7
    s_lshl_b32 s39, s92, 7
    s_add_u32 m0, s38, 24576
    s_add_u32 s39, s39, s10
    buffer_load_dwordx4 v14, s[40:43], s39 offen lds
    v_mfma_f32_32x32x16_bf16 v[144:159], v[68:71], a[4:7], v[144:159]
    ds_read_b128 a[20:23], v193 offset:8192
    ds_read_b64_tr_b16 v[84:85], v201 offset:10240
    ds_read_b64_tr_b16 v[86:87], v201 offset:10752
    ds_read_b128 v[220:223], v197 offset:8192
    buffer_load_dwordx4 v179, s[40:43], s39 offen offset:1024 lds
    v_mfma_f32_32x32x16_bf16 v[144:159], v[72:75], a[8:11], v[144:159]
    ds_read_b128 a[24:27], v194 offset:8192
    ds_read_b64_tr_b16 v[88:89], v201 offset:12288
    ds_read_b64_tr_b16 v[90:91], v201 offset:12800
    s_lshl_b32 s39, s92, 16
    s_add_u32 m0, s38, 92160
    s_add_u32 s39, s39, s11
    buffer_load_dwordx4 v5, s[52:55], s39 offen lds
    v_mfma_f32_32x32x16_bf16 v[144:159], v[76:79], a[12:15], v[144:159]
    ds_read_b128 a[28:31], v195 offset:8192
    ds_read_b64_tr_b16 v[92:93], v201 offset:14336
    ds_read_b64_tr_b16 v[94:95], v201 offset:14848
    buffer_load_dwordx4 v136, s[52:55], s39 offen offset:1024 lds
    v_dot2c_f32_bf16 v202, s80, v208
    v_dot2c_f32_bf16 v204, v208, v208
    v_dot2c_f32_bf16 v203, s80, v209
    v_dot2c_f32_bf16 v205, v209, v209
    v_dot2c_f32_bf16 v202, s80, v210
    v_dot2c_f32_bf16 v204, v210, v210
    v_dot2c_f32_bf16 v203, s80, v211
    v_dot2c_f32_bf16 v205, v211, v211
    v_dot2c_f32_bf16 v202, s80, v212
    v_dot2c_f32_bf16 v204, v212, v212
    v_dot2c_f32_bf16 v203, s80, v213
    v_dot2c_f32_bf16 v205, v213, v213
    v_dot2c_f32_bf16 v202, s80, v214
    v_dot2c_f32_bf16 v204, v214, v214
    v_dot2c_f32_bf16 v203, s80, v215
    v_dot2c_f32_bf16 v205, v215, v215
    s_cmp_lg_u32 s4, 0
    s_cbranch_scc1 L_cs_6
    v_dot2c_f32_bf16 v206, s80, v64
    v_dot2c_f32_bf16 v207, s80, v65
    v_dot2c_f32_bf16 v206, s80, v66
    v_dot2c_f32_bf16 v207, s80, v67
    v_dot2c_f32_bf16 v206, s80, v68
    v_dot2c_f32_bf16 v207, s80, v69
    v_dot2c_f32_bf16 v206, s80, v70
    v_dot2c_f32_bf16 v207, s80, v71
    s_branch L_ce_7
L_cs_6:
    v_dot2c_f32_bf16 v206, s80, v72
    v_dot2c_f32_bf16 v207, s80, v73
    v_dot2c_f32_bf16 v206, s80, v74
    v_dot2c_f32_bf16 v207, s80, v75
    v_dot2c_f32_bf16 v206, s80, v76
    v_dot2c_f32_bf16 v207, s80, v77
    v_dot2c_f32_bf16 v206, s80, v78
    v_dot2c_f32_bf16 v207, s80, v79
L_ce_7:
    s_waitcnt vmcnt(4)
    s_cmp_lg_u32 s2, 0
    s_cbranch_scc1 L_fi_8
    s_cmp_lg_u32 s3, 3
    s_cbranch_scc1 L_fi_8
    v_mov_b32 v250, 0
    v_mov_b32 v251, 1
    s_mov_b64 s[94:95], exec
    s_mov_b64 exec, 1
    buffer_store_dword v251, v250, s[76:79], 0 offen sc1
    s_mov_b64 exec, s[94:95]
L_fi_8:
    s_waitcnt lgkmcnt(0)
    s_barrier
    s_cmp_lg_u32 s26, 2
    s_cbranch_scc1 L_xr_9
    v_xor_b32 v224, 0, v200
    ds_read_b64 v[16:17], v224
    v_xor_b32 v224, 16, v200
    ds_read_b64 v[18:19], v224
    v_xor_b32 v224, 32, v200
    ds_read_b64 v[20:21], v224
    v_xor_b32 v224, 48, v200
    ds_read_b64 v[22:23], v224
L_xr_9:
    v_mfma_f32_32x32x16_bf16 v[144:159], v[80:83], a[16:19], v[144:159]
    ds_read_b128 a[32:35], v192 offset:16384
    ds_read_b64_tr_b16 v[64:65], v201 offset:16384
    ds_read_b64_tr_b16 v[66:67], v201 offset:16896
    ds_read_b128 v[208:211], v196 offset:16384
    s_add_u32 s92, s14, 4
    s_and_b32 s92, s92, 7
    s_lshl_b32 s39, s92, 7
    s_add_u32 m0, s38, 32768
    s_add_u32 s39, s39, s10
    buffer_load_dwordx4 v14, s[40:43], s39 offen lds
    v_mfma_f32_32x32x16_bf16 v[144:159], v[84:87], a[20:23], v[144:159]
    ds_read_b128 a[36:39], v193 offset:16384
    ds_read_b64_tr_b16 v[68:69], v201 offset:18432
    ds_read_b64_tr_b16 v[70:71], v201 offset:18944
    ds_read_b128 v[212:215], v197 offset:16384
    buffer_load_dwordx4 v179, s[40:43], s39 offen offset:1024 lds
    v_mfma_f32_32x32x16_bf16 v[144:159], v[88:91], a[24:27], v[144:159]
    ds_read_b128 a[40:43], v194 offset:16384
    ds_read_b64_tr_b16 v[72:73], v201 offset:20480
    ds_read_b64_tr_b16 v[74:75], v201 offset:20992
    s_lshl_b32 s39, s92, 16
    s_add_u32 m0, s38, 100352
    s_add_u32 s39, s39, s11
    buffer_load_dwordx4 v5, s[52:55], s39 offen lds
    v_mfma_f32_32x32x16_bf16 v[144:159], v[92:95], a[28:31], v[144:159]
    ds_read_b128 a[44:47], v195 offset:16384
    ds_read_b64_tr_b16 v[76:77], v201 offset:22528
    ds_read_b64_tr_b16 v[78:79], v201 offset:23040
    buffer_load_dwordx4 v136, s[52:55], s39 offen offset:1024 lds
    v_dot2c_f32_bf16 v202, s80, v216
    v_dot2c_f32_bf16 v204, v216, v216
    v_dot2c_f32_bf16 v203, s80, v217
    v_dot2c_f32_bf16 v205, v217, v217
    v_dot2c_f32_bf16 v202, s80, v218
    v_dot2c_f32_bf16 v204, v218, v218
    v_dot2c_f32_bf16 v203, s80, v219
    v_dot2c_f32_bf16 v205, v219, v219
    v_dot2c_f32_bf16 v202, s80, v220
    v_dot2c_f32_bf16 v204, v220, v220
    v_dot2c_f32_bf16 v203, s80, v221
    v_dot2c_f32_bf16 v205, v221, v221
    v_dot2c_f32_bf16 v202, s80, v222
    v_dot2c_f32_bf16 v204, v222, v222
    v_dot2c_f32_bf16 v203, s80, v223
    v_dot2c_f32_bf16 v205, v223, v223
    s_cmp_lg_u32 s4, 0
    s_cbranch_scc1 L_cs_10
    v_dot2c_f32_bf16 v206, s80, v80
    v_dot2c_f32_bf16 v207, s80, v81
    v_dot2c_f32_bf16 v206, s80, v82
    v_dot2c_f32_bf16 v207, s80, v83
    v_dot2c_f32_bf16 v206, s80, v84
    v_dot2c_f32_bf16 v207, s80, v85
    v_dot2c_f32_bf16 v206, s80, v86
    v_dot2c_f32_bf16 v207, s80, v87
    s_branch L_ce_11
L_cs_10:
    v_dot2c_f32_bf16 v206, s80, v88
    v_dot2c_f32_bf16 v207, s80, v89
    v_dot2c_f32_bf16 v206, s80, v90
    v_dot2c_f32_bf16 v207, s80, v91
    v_dot2c_f32_bf16 v206, s80, v92
    v_dot2c_f32_bf16 v207, s80, v93
    v_dot2c_f32_bf16 v206, s80, v94
    v_dot2c_f32_bf16 v207, s80, v95
L_ce_11:
    s_waitcnt vmcnt(4)
    s_waitcnt lgkmcnt(0)
    s_barrier
    v_mfma_f32_32x32x16_bf16 v[144:159], v[64:67], a[32:35], v[144:159]
    ds_read_b128 a[48:51], v192 offset:24576
    ds_read_b64_tr_b16 v[80:81], v201 offset:24576
    ds_read_b64_tr_b16 v[82:83], v201 offset:25088
    ds_read_b128 v[216:219], v196 offset:24576
    s_add_u32 s92, s14, 5
    s_and_b32 s92, s92, 7
    s_lshl_b32 s39, s92, 7
    s_add_u32 m0, s38, 40960
    s_add_u32 s39, s39, s10
    buffer_load_dwordx4 v14, s[40:43], s39 offen lds
    v_mfma_f32_32x32x16_bf16 v[144:159], v[68:71], a[36:39], v[144:159]
    ds_read_b128 a[52:55], v193 offset:24576
    ds_read_b64_tr_b16 v[84:85], v201 offset:26624
    ds_read_b64_tr_b16 v[86:87], v201 offset:27136
    ds_read_b128 v[220:223], v197 offset:24576
    buffer_load_dwordx4 v179, s[40:43], s39 offen offset:1024 lds
    v_mfma_f32_32x32x16_bf16 v[144:159], v[72:75], a[40:43], v[144:159]
    ds_read_b128 a[56:59], v194 offset:24576
    ds_read_b64_tr_b16 v[88:89], v201 offset:28672
    ds_read_b64_tr_b16 v[90:91], v201 offset:29184
    s_lshl_b32 s39, s92, 16
    s_add_u32 m0, s38, 108544
    s_add_u32 s39, s39, s11
    buffer_load_dwordx4 v5, s[52:55], s39 offen lds
    v_mfma_f32_32x32x16_bf16 v[144:159], v[76:79], a[44:47], v[144:159]
    ds_read_b128 a[60:63], v195 offset:24576
    ds_read_b64_tr_b16 v[92:93], v201 offset:30720
    ds_read_b64_tr_b16 v[94:95], v201 offset:31232
    buffer_load_dwordx4 v136, s[52:55], s39 offen offset:1024 lds
    v_dot2c_f32_bf16 v202, s80, v208
    v_dot2c_f32_bf16 v204, v208, v208
    v_dot2c_f32_bf16 v203, s80, v209
    v_dot2c_f32_bf16 v205, v209, v209
    v_dot2c_f32_bf16 v202, s80, v210
    v_dot2c_f32_bf16 v204, v210, v210
    v_dot2c_f32_bf16 v203, s80, v211
    v_dot2c_f32_bf16 v205, v211, v211
    v_dot2c_f32_bf16 v202, s80, v212
    v_dot2c_f32_bf16 v204, v212, v212
    v_dot2c_f32_bf16 v203, s80, v213
    v_dot2c_f32_bf16 v205, v213, v213
    v_dot2c_f32_bf16 v202, s80, v214
    v_dot2c_f32_bf16 v204, v214, v214
    v_dot2c_f32_bf16 v203, s80, v215
    v_dot2c_f32_bf16 v205, v215, v215
    s_cmp_lg_u32 s4, 0
    s_cbranch_scc1 L_cs_12
    v_dot2c_f32_bf16 v206, s80, v64
    v_dot2c_f32_bf16 v207, s80, v65
    v_dot2c_f32_bf16 v206, s80, v66
    v_dot2c_f32_bf16 v207, s80, v67
    v_dot2c_f32_bf16 v206, s80, v68
    v_dot2c_f32_bf16 v207, s80, v69
    v_dot2c_f32_bf16 v206, s80, v70
    v_dot2c_f32_bf16 v207, s80, v71
    s_branch L_ce_13
L_cs_12:
    v_dot2c_f32_bf16 v206, s80, v72
    v_dot2c_f32_bf16 v207, s80, v73
    v_dot2c_f32_bf16 v206, s80, v74
    v_dot2c_f32_bf16 v207, s80, v75
    v_dot2c_f32_bf16 v206, s80, v76
    v_dot2c_f32_bf16 v207, s80, v77
    v_dot2c_f32_bf16 v206, s80, v78
    v_dot2c_f32_bf16 v207, s80, v79
L_ce_13:
    s_waitcnt vmcnt(4)
    s_waitcnt lgkmcnt(0)
    s_barrier
    s_cmp_lg_u32 s26, 4
    s_cbranch_scc1 L_xr_14
    v_xor_b32 v224, 0, v200
    ds_read_b64 v[16:17], v224
    v_xor_b32 v224, 16, v200
    ds_read_b64 v[18:19], v224
    v_xor_b32 v224, 32, v200
    ds_read_b64 v[20:21], v224
    v_xor_b32 v224, 48, v200
    ds_read_b64 v[22:23], v224
L_xr_14:
    v_mfma_f32_32x32x16_bf16 v[144:159], v[80:83], a[48:51], v[144:159]
    ds_read_b128 a[64:67], v192 offset:32768
    ds_read_b64_tr_b16 v[64:65], v201 offset:32768
    ds_read_b64_tr_b16 v[66:67], v201 offset:33280
    ds_read_b128 v[208:211], v196 offset:32768
    s_add_u32 s92, s14, 6
    s_and_b32 s92, s92, 7
    s_lshl_b32 s39, s92, 7
    s_add_u32 m0, s38, 49152
    s_add_u32 s39, s39, s10
    buffer_load_dwordx4 v14, s[40:43], s39 offen lds
    v_mfma_f32_32x32x16_bf16 v[144:159], v[84:87], a[52:55], v[144:159]
    ds_read_b128 a[68:71], v193 offset:32768
    ds_read_b64_tr_b16 v[68:69], v201 offset:34816
    ds_read_b64_tr_b16 v[70:71], v201 offset:35328
    ds_read_b128 v[212:215], v197 offset:32768
    buffer_load_dwordx4 v179, s[40:43], s39 offen offset:1024 lds
    v_mfma_f32_32x32x16_bf16 v[144:159], v[88:91], a[56:59], v[144:159]
    ds_read_b128 a[72:75], v194 offset:32768
    ds_read_b64_tr_b16 v[72:73], v201 offset:36864
    ds_read_b64_tr_b16 v[74:75], v201 offset:37376
    s_lshl_b32 s39, s92, 16
    s_add_u32 m0, s38, 116736
    s_add_u32 s39, s39, s11
    buffer_load_dwordx4 v5, s[52:55], s39 offen lds
    v_mfma_f32_32x32x16_bf16 v[144:159], v[92:95], a[60:63], v[144:159]
    ds_read_b128 a[76:79], v195 offset:32768
    ds_read_b64_tr_b16 v[76:77], v201 offset:38912
    ds_read_b64_tr_b16 v[78:79], v201 offset:39424
    buffer_load_dwordx4 v136, s[52:55], s39 offen offset:1024 lds
    v_dot2c_f32_bf16 v202, s80, v216
    v_dot2c_f32_bf16 v204, v216, v216
    v_dot2c_f32_bf16 v203, s80, v217
    v_dot2c_f32_bf16 v205, v217, v217
    v_dot2c_f32_bf16 v202, s80, v218
    v_dot2c_f32_bf16 v204, v218, v218
    v_dot2c_f32_bf16 v203, s80, v219
    v_dot2c_f32_bf16 v205, v219, v219
    v_dot2c_f32_bf16 v202, s80, v220
    v_dot2c_f32_bf16 v204, v220, v220
    v_dot2c_f32_bf16 v203, s80, v221
    v_dot2c_f32_bf16 v205, v221, v221
    v_dot2c_f32_bf16 v202, s80, v222
    v_dot2c_f32_bf16 v204, v222, v222
    v_dot2c_f32_bf16 v203, s80, v223
    v_dot2c_f32_bf16 v205, v223, v223
    s_cmp_lg_u32 s4, 0
    s_cbranch_scc1 L_cs_15
    v_dot2c_f32_bf16 v206, s80, v80
    v_dot2c_f32_bf16 v207, s80, v81
    v_dot2c_f32_bf16 v206, s80, v82
    v_dot2c_f32_bf16 v207, s80, v83
    v_dot2c_f32_bf16 v206, s80, v84
    v_dot2c_f32_bf16 v207, s80, v85
    v_dot2c_f32_bf16 v206, s80, v86
    v_dot2c_f32_bf16 v207, s80, v87
    s_branch L_ce_16
L_cs_15:
    v_dot2c_f32_bf16 v206, s80, v88
    v_dot2c_f32_bf16 v207, s80, v89
    v_dot2c_f32_bf16 v206, s80, v90
    v_dot2c_f32_bf16 v207, s80, v91
    v_dot2c_f32_bf16 v206, s80, v92
    v_dot2c_f32_bf16 v207, s80, v93
    v_dot2c_f32_bf16 v206, s80, v94
    v_dot2c_f32_bf16 v207, s80, v95
L_ce_16:
    s_waitcnt vmcnt(4)
    s_waitcnt lgkmcnt(0)
    s_barrier
    s_mov_b64 s[94:95], exec
    s_mov_b64 exec, 1
    s_add_u32 s97, s19, 2031616
    buffer_load_dword v255, v246, s[72:75], s97 offen
    s_mov_b64 exec, s[94:95]
    v_mfma_f32_32x32x16_bf16 v[144:159], v[64:67], a[64:67], v[144:159]
    ds_read_b128 a[80:83], v192 offset:40960
    ds_read_b64_tr_b16 v[80:81], v201 offset:40960
    ds_read_b64_tr_b16 v[82:83], v201 offset:41472
    ds_read_b128 v[216:219], v196 offset:40960
    s_add_u32 s92, s14, 7
    s_and_b32 s92, s92, 7
    s_lshl_b32 s39, s92, 7
    s_add_u32 m0, s38, 57344
    s_add_u32 s39, s39, s10
    buffer_load_dwordx4 v14, s[40:43], s39 offen lds
    v_mfma_f32_32x32x16_bf16 v[144:159], v[68:71], a[68:71], v[144:159]
    ds_read_b128 a[84:87], v193 offset:40960
    ds_read_b64_tr_b16 v[84:85], v201 offset:43008
    ds_read_b64_tr_b16 v[86:87], v201 offset:43520
    ds_read_b128 v[220:223], v197 offset:40960
    buffer_load_dwordx4 v179, s[40:43], s39 offen offset:1024 lds
    v_mfma_f32_32x32x16_bf16 v[144:159], v[72:75], a[72:75], v[144:159]
    ds_read_b128 a[88:91], v194 offset:40960
    ds_read_b64_tr_b16 v[88:89], v201 offset:45056
    ds_read_b64_tr_b16 v[90:91], v201 offset:45568
    s_lshl_b32 s39, s92, 16
    s_add_u32 m0, s38, 124928
    s_add_u32 s39, s39, s11
    buffer_load_dwordx4 v5, s[52:55], s39 offen lds
    v_mfma_f32_32x32x16_bf16 v[144:159], v[76:79], a[76:79], v[144:159]
    ds_read_b128 a[92:95], v195 offset:40960
    ds_read_b64_tr_b16 v[92:93], v201 offset:47104
    ds_read_b64_tr_b16 v[94:95], v201 offset:47616
    buffer_load_dwordx4 v136, s[52:55], s39 offen offset:1024 lds
    v_dot2c_f32_bf16 v202, s80, v208
    v_dot2c_f32_bf16 v204, v208, v208
    v_dot2c_f32_bf16 v203, s80, v209
    v_dot2c_f32_bf16 v205, v209, v209
    v_dot2c_f32_bf16 v202, s80, v210
    v_dot2c_f32_bf16 v204, v210, v210
    v_dot2c_f32_bf16 v203, s80, v211
    v_dot2c_f32_bf16 v205, v211, v211
    v_dot2c_f32_bf16 v202, s80, v212
    v_dot2c_f32_bf16 v204, v212, v212
    v_dot2c_f32_bf16 v203, s80, v213
    v_dot2c_f32_bf16 v205, v213, v213
    v_dot2c_f32_bf16 v202, s80, v214
    v_dot2c_f32_bf16 v204, v214, v214
    v_dot2c_f32_bf16 v203, s80, v215
    v_dot2c_f32_bf16 v205, v215, v215
    s_cmp_lg_u32 s4, 0
    s_cbranch_scc1 L_cs_17
    v_dot2c_f32_bf16 v206, s80, v64
    v_dot2c_f32_bf16 v207, s80, v65
    v_dot2c_f32_bf16 v206, s80, v66
    v_dot2c_f32_bf16 v207, s80, v67
    v_dot2c_f32_bf16 v206, s80, v68
    v_dot2c_f32_bf16 v207, s80, v69
    v_dot2c_f32_bf16 v206, s80, v70
    v_dot2c_f32_bf16 v207, s80, v71
    s_branch L_ce_18
L_cs_17:
    v_dot2c_f32_bf16 v206, s80, v72
    v_dot2c_f32_bf16 v207, s80, v73
    v_dot2c_f32_bf16 v206, s80, v74
    v_dot2c_f32_bf16 v207, s80, v75
    v_dot2c_f32_bf16 v206, s80, v76
    v_dot2c_f32_bf16 v207, s80, v77
    v_dot2c_f32_bf16 v206, s80, v78
    v_dot2c_f32_bf16 v207, s80, v79
L_ce_18:
    s_waitcnt vmcnt(5)
    s_waitcnt lgkmcnt(0)
    s_barrier
    s_cmp_lg_u32 s26, 6
    s_cbranch_scc1 L_xr_19
    v_xor_b32 v224, 0, v200
    ds_read_b64 v[16:17], v224
    v_xor_b32 v224, 16, v200
    ds_read_b64 v[18:19], v224
    v_xor_b32 v224, 32, v200
    ds_read_b64 v[20:21], v224
    v_xor_b32 v224, 48, v200
    ds_read_b64 v[22:23], v224
L_xr_19:
    s_cmp_lg_u32 s3, 3
    s_cbranch_scc1 L_iiskip_20
    buffer_load_dword v247, v246, s[76:79], 0 offen sc1
L_iiskip_20:
    v_mfma_f32_32x32x16_bf16 v[144:159], v[80:83], a[80:83], v[144:159]
    ds_read_b128 a[96:99], v192 offset:49152
    ds_read_b64_tr_b16 v[64:65], v201 offset:49152
    ds_read_b64_tr_b16 v[66:67], v201 offset:49664
    ds_read_b128 v[208:211], v196 offset:49152
    s_add_u32 m0, s12, 133120
    s_add_u32 s39, s15, 0
    s_and_b32 s39, s39, 63
    s_mul_i32 s39, s39, 24576
    s_lshl_b32 s83, s7, 7
    s_add_u32 s83, s83, s39
    s_add_u32 s83, s83, 1024
    buffer_load_dwordx4 v6, s[44:47], s83 offen lds
    buffer_load_dwordx4 v141, s[44:47], s83 offen offset:1024 lds
    v_mfma_f32_32x32x16_bf16 v[144:159], v[84:87], a[84:87], v[144:159]
    ds_read_b128 a[100:103], v193 offset:49152
    ds_read_b64_tr_b16 v[68:69], v201 offset:51200
    ds_read_b64_tr_b16 v[70:71], v201 offset:51712
    ds_read_b128 v[212:215], v197 offset:49152
    buffer_load_dwordx4 v142, s[44:47], s83 offen offset:2048 lds
    buffer_load_dwordx4 v143, s[44:47], s83 offen offset:3072 lds
    v_mfma_f32_32x32x16_bf16 v[144:159], v[88:91], a[88:91], v[144:159]
    ds_read_b128 a[104:107], v194 offset:49152
    ds_read_b64_tr_b16 v[72:73], v201 offset:53248
    ds_read_b64_tr_b16 v[74:75], v201 offset:53760
    s_add_u32 m0, s12, 0
    s_add_u32 s39, s15, 16
    s_and_b32 s39, s39, 63
    s_mul_i32 s39, s39, 24576
    s_lshl_b32 s83, s7, 7
    s_add_u32 s83, s83, s39
    s_add_u32 s83, s83, 1024
    buffer_load_dwordx4 v6, s[44:47], s83 offen lds
    buffer_load_dwordx4 v141, s[44:47], s83 offen offset:1024 lds
    v_mfma_f32_32x32x16_bf16 v[144:159], v[92:95], a[92:95], v[144:159]
    ds_read_b128 a[108:111], v195 offset:49152
    ds_read_b64_tr_b16 v[76:77], v201 offset:55296
    ds_read_b64_tr_b16 v[78:79], v201 offset:55808
    buffer_load_dwordx4 v142, s[44:47], s83 offen offset:2048 lds
    buffer_load_dwordx4 v143, s[44:47], s83 offen offset:3072 lds
    v_dot2c_f32_bf16 v202, s80, v216
    v_dot2c_f32_bf16 v204, v216, v216
    v_dot2c_f32_bf16 v203, s80, v217
    v_dot2c_f32_bf16 v205, v217, v217
    v_dot2c_f32_bf16 v202, s80, v218
    v_dot2c_f32_bf16 v204, v218, v218
    v_dot2c_f32_bf16 v203, s80, v219
    v_dot2c_f32_bf16 v205, v219, v219
    v_dot2c_f32_bf16 v202, s80, v220
    v_dot2c_f32_bf16 v204, v220, v220
    v_dot2c_f32_bf16 v203, s80, v221
    v_dot2c_f32_bf16 v205, v221, v221
    v_dot2c_f32_bf16 v202, s80, v222
    v_dot2c_f32_bf16 v204, v222, v222
    v_dot2c_f32_bf16 v203, s80, v223
    v_dot2c_f32_bf16 v205, v223, v223
    s_cmp_lg_u32 s4, 0
    s_cbranch_scc1 L_cs_21
    v_dot2c_f32_bf16 v206, s80, v80
    v_dot2c_f32_bf16 v207, s80, v81
    v_dot2c_f32_bf16 v206, s80, v82
    v_dot2c_f32_bf16 v207, s80, v83
    v_dot2c_f32_bf16 v206, s80, v84
    v_dot2c_f32_bf16 v207, s80, v85
    v_dot2c_f32_bf16 v206, s80, v86
    v_dot2c_f32_bf16 v207, s80, v87
    s_branch L_ce_22
L_cs_21:
    v_dot2c_f32_bf16 v206, s80, v88
    v_dot2c_f32_bf16 v207, s80, v89
    v_dot2c_f32_bf16 v206, s80, v90
    v_dot2c_f32_bf16 v207, s80, v91
    v_dot2c_f32_bf16 v206, s80, v92
    v_dot2c_f32_bf16 v207, s80, v93
    v_dot2c_f32_bf16 v206, s80, v94
    v_dot2c_f32_bf16 v207, s80, v95
L_ce_22:
    s_waitcnt vmcnt(8)
    s_waitcnt lgkmcnt(0)
    s_barrier
    v_mfma_f32_32x32x16_bf16 v[144:159], v[64:67], a[96:99], v[144:159]
    ds_read_b128 a[112:115], v192 offset:57344
    ds_read_b64_tr_b16 v[80:81], v201 offset:57344
    ds_read_b64_tr_b16 v[82:83], v201 offset:57856
    ds_read_b128 v[216:219], v196 offset:57344
    s_add_u32 m0, s12, 16384
    s_add_u32 s39, s15, 32
    s_and_b32 s39, s39, 63
    s_mul_i32 s39, s39, 24576
    s_lshl_b32 s83, s7, 7
    s_add_u32 s83, s83, s39
    s_add_u32 s83, s83, 1024
    buffer_load_dwordx4 v6, s[44:47], s83 offen lds
    buffer_load_dwordx4 v141, s[44:47], s83 offen offset:1024 lds
    v_mfma_f32_32x32x16_bf16 v[144:159], v[68:71], a[100:103], v[144:159]
    ds_read_b128 a[116:119], v193 offset:57344
    ds_read_b64_tr_b16 v[84:85], v201 offset:59392
    ds_read_b64_tr_b16 v[86:87], v201 offset:59904
    ds_read_b128 v[220:223], v197 offset:57344
    buffer_load_dwordx4 v142, s[44:47], s83 offen offset:2048 lds
    buffer_load_dwordx4 v143, s[44:47], s83 offen offset:3072 lds
    v_mfma_f32_32x32x16_bf16 v[144:159], v[72:75], a[104:107], v[144:159]
    ds_read_b128 a[120:123], v194 offset:57344
    ds_read_b64_tr_b16 v[88:89], v201 offset:61440
    ds_read_b64_tr_b16 v[90:91], v201 offset:61952
    s_add_u32 m0, s12, 32768
    s_add_u32 s39, s15, 48
    s_and_b32 s39, s39, 63
    s_mul_i32 s39, s39, 24576
    s_lshl_b32 s83, s7, 7
    s_add_u32 s83, s83, s39
    s_add_u32 s83, s83, 1024
    buffer_load_dwordx4 v6, s[44:47], s83 offen lds
    buffer_load_dwordx4 v141, s[44:47], s83 offen offset:1024 lds
    v_mfma_f32_32x32x16_bf16 v[144:159], v[76:79], a[108:111], v[144:159]
    ds_read_b128 a[124:127], v195 offset:57344
    ds_read_b64_tr_b16 v[92:93], v201 offset:63488
    ds_read_b64_tr_b16 v[94:95], v201 offset:64000
    buffer_load_dwordx4 v142, s[44:47], s83 offen offset:2048 lds
    buffer_load_dwordx4 v143, s[44:47], s83 offen offset:3072 lds
    v_dot2c_f32_bf16 v202, s80, v208
    v_dot2c_f32_bf16 v204, v208, v208
    v_dot2c_f32_bf16 v203, s80, v209
    v_dot2c_f32_bf16 v205, v209, v209
    v_dot2c_f32_bf16 v202, s80, v210
    v_dot2c_f32_bf16 v204, v210, v210
    v_dot2c_f32_bf16 v203, s80, v211
    v_dot2c_f32_bf16 v205, v211, v211
    v_dot2c_f32_bf16 v202, s80, v212
    v_dot2c_f32_bf16 v204, v212, v212
    v_dot2c_f32_bf16 v203, s80, v213
    v_dot2c_f32_bf16 v205, v213, v213
    v_dot2c_f32_bf16 v202, s80, v214
    v_dot2c_f32_bf16 v204, v214, v214
    v_dot2c_f32_bf16 v203, s80, v215
    v_dot2c_f32_bf16 v205, v215, v215
    s_cmp_lg_u32 s4, 0
    s_cbranch_scc1 L_cs_23
    v_dot2c_f32_bf16 v206, s80, v64
    v_dot2c_f32_bf16 v207, s80, v65
    v_dot2c_f32_bf16 v206, s80, v66
    v_dot2c_f32_bf16 v207, s80, v67
    v_dot2c_f32_bf16 v206, s80, v68
    v_dot2c_f32_bf16 v207, s80, v69
    v_dot2c_f32_bf16 v206, s80, v70
    v_dot2c_f32_bf16 v207, s80, v71
    s_branch L_ce_24
L_cs_23:
    v_dot2c_f32_bf16 v206, s80, v72
    v_dot2c_f32_bf16 v207, s80, v73
    v_dot2c_f32_bf16 v206, s80, v74
    v_dot2c_f32_bf16 v207, s80, v75
    v_dot2c_f32_bf16 v206, s80, v76
    v_dot2c_f32_bf16 v207, s80, v77
    v_dot2c_f32_bf16 v206, s80, v78
    v_dot2c_f32_bf16 v207, s80, v79
L_ce_24:
    s_waitcnt lgkmcnt(0)
    v_mfma_f32_32x32x16_bf16 v[144:159], v[80:83], a[112:115], v[144:159]
    s_add_u32 m0, s12, 67584
    s_add_u32 s39, s15, 0
    s_and_b32 s39, s39, 63
    s_mul_i32 s39, s39, 24576
    s_lshl_b32 s83, s7, 7
    s_add_u32 s83, s83, s39
    s_add_u32 s83, s83, 2048
    buffer_load_dwordx4 v6, s[44:47], s83 offen lds
    buffer_load_dwordx4 v141, s[44:47], s83 offen offset:1024 lds
    v_mfma_f32_32x32x16_bf16 v[144:159], v[84:87], a[116:119], v[144:159]
    buffer_load_dwordx4 v142, s[44:47], s83 offen offset:2048 lds
    buffer_load_dwordx4 v143, s[44:47], s83 offen offset:3072 lds
    v_mfma_f32_32x32x16_bf16 v[144:159], v[88:91], a[120:123], v[144:159]
    s_add_u32 m0, s12, 83968
    s_add_u32 s39, s15, 16
    s_and_b32 s39, s39, 63
    s_mul_i32 s39, s39, 24576
    s_lshl_b32 s83, s7, 7
    s_add_u32 s83, s83, s39
    s_add_u32 s83, s83, 2048
    buffer_load_dwordx4 v6, s[44:47], s83 offen lds
    buffer_load_dwordx4 v141, s[44:47], s83 offen offset:1024 lds
    v_mfma_f32_32x32x16_bf16 v[144:159], v[92:95], a[124:127], v[144:159]
    buffer_load_dwordx4 v142, s[44:47], s83 offen offset:2048 lds
    buffer_load_dwordx4 v143, s[44:47], s83 offen offset:3072 lds
    v_dot2c_f32_bf16 v202, s80, v216
    v_dot2c_f32_bf16 v204, v216, v216
    v_dot2c_f32_bf16 v203, s80, v217
    v_dot2c_f32_bf16 v205, v217, v217
    v_dot2c_f32_bf16 v202, s80, v218
    v_dot2c_f32_bf16 v204, v218, v218
    v_dot2c_f32_bf16 v203, s80, v219
    v_dot2c_f32_bf16 v205, v219, v219
    v_dot2c_f32_bf16 v202, s80, v220
    v_dot2c_f32_bf16 v204, v220, v220
    v_dot2c_f32_bf16 v203, s80, v221
    v_dot2c_f32_bf16 v205, v221, v221
    v_dot2c_f32_bf16 v202, s80, v222
    v_dot2c_f32_bf16 v204, v222, v222
    v_dot2c_f32_bf16 v203, s80, v223
    v_dot2c_f32_bf16 v205, v223, v223
    s_cmp_lg_u32 s4, 0
    s_cbranch_scc1 L_cs_25
    v_dot2c_f32_bf16 v206, s80, v80
    v_dot2c_f32_bf16 v207, s80, v81
    v_dot2c_f32_bf16 v206, s80, v82
    v_dot2c_f32_bf16 v207, s80, v83
    v_dot2c_f32_bf16 v206, s80, v84
    v_dot2c_f32_bf16 v207, s80, v85
    v_dot2c_f32_bf16 v206, s80, v86
    v_dot2c_f32_bf16 v207, s80, v87
    s_branch L_ce_26
L_cs_25:
    v_dot2c_f32_bf16 v206, s80, v88
    v_dot2c_f32_bf16 v207, s80, v89
    v_dot2c_f32_bf16 v206, s80, v90
    v_dot2c_f32_bf16 v207, s80, v91
    v_dot2c_f32_bf16 v206, s80, v92
    v_dot2c_f32_bf16 v207, s80, v93
    v_dot2c_f32_bf16 v206, s80, v94
    v_dot2c_f32_bf16 v207, s80, v95
L_ce_26:
    s_nop 2
    v_add_f32 v202, v202, v203
    v_add_f32 v204, v204, v205
    v_add_f32 v206, v206, v207
    v_mov_b32 v225, v202
    v_mov_b32 v226, v204
    s_nop 0
    v_permlane32_swap_b32 v202, v225
    v_permlane32_swap_b32 v204, v226
    v_add_f32 v202, v202, v225
    v_add_f32 v204, v204, v226
    v_mov_b32 v225, v206
    s_nop 1
    v_permlane32_swap_b32 v206, v225
    s_nop 0
    v_add_f32 v206, v206, v225
    s_lshl_b32 s85, s3, 8
    v_lshl_add_u32 v225, v2, 3, s85
    v_add_u32 v225, 160768, v225
    v_mov_b32 v203, v204
    ds_write_b64 v225, v[202:203]
    s_lshl_b32 s85, s3, 7
    v_lshl_add_u32 v226, v2, 2, s85
    v_add_u32 v226, 161792, v226
    ds_write_b32 v226, v206
    s_waitcnt lgkmcnt(0)
    s_barrier
    v_xor_b32 v225, 512, v225
    v_xor_b32 v226, 128, v226
    ds_read_b64 v[204:205], v225
    ds_read_b32 v207, v226
    v_cmp_gt_u32 vcc, 32, v1
    s_waitcnt lgkmcnt(0)
    v_add_f32 v202, v202, v204
    v_add_f32 v203, v203, v205
    v_add_f32 v206, v206, v207
    v_cndmask_b32 v206, 0, v206, vcc
    v_mul_f32 v202, 0x3b000000, v202
    v_mul_f32 v203, 0x3b000000, v203
    v_sub_f32 v14, 0, v202
    v_fma_f32 v203, v14, v202, v203
    v_max_f32 v203, 0, v203
    v_mfma_f32_32x32x2_f32 v[144:159], v206, v14, v[144:159]
    s_add_u32 m0, s12, 100352
    s_add_u32 s39, s15, 32
    s_and_b32 s39, s39, 63
    s_mul_i32 s39, s39, 24576
    s_lshl_b32 s83, s7, 7
    s_add_u32 s83, s83, s39
    s_add_u32 s83, s83, 2048
    buffer_load_dwordx4 v6, s[44:47], s83 offen lds
    v_add_f32 v204, 0x3727c5ac, v203
    v_rsq_f32 v15, v204
    s_nop 0
    v_mul_f32 v204, v15, v15
    v_mul_f32 v204, v204, v203
    v_add_f32 v204, 0x3727c5ac, v204
    v_rsq_f32 v204, v204
    s_nop 0
    v_mul_f32 v204, v204, v15
    v_mul_f32 v228, 0xc0135761, v204
    v_mul_f32 v226, v204, v204
    v_mul_f32 v226, v226, v204
    v_mul_f32 v226, 0xbdd2d3e8, v226
    v_rcp_f32 v230, v204
    buffer_load_dwordx4 v141, s[44:47], s83 offen offset:1024 lds
    v_mov_b32 v229, v228
    v_mov_b32 v227, v226
    v_mov_b32 v231, v230
    v_pk_mul_f32 v[232:233], v[144:145], v[144:145]
    v_pk_mul_f32 v[234:235], v[146:147], v[146:147]
    v_pk_fma_f32 v[232:233], v[232:233], v[226:227], v[228:229]
    v_pk_fma_f32 v[234:235], v[234:235], v[226:227], v[228:229]
    v_pk_mul_f32 v[232:233], v[232:233], v[144:145]
    v_pk_mul_f32 v[234:235], v[234:235], v[146:147]
    v_exp_f32 v232, v232
    v_exp_f32 v233, v233
    v_exp_f32 v234, v234
    v_exp_f32 v235, v235
    buffer_load_dwordx4 v142, s[44:47], s83 offen offset:2048 lds
    v_pk_fma_f32 v[232:233], v[232:233], v[230:231], v[230:231]
    v_pk_fma_f32 v[234:235], v[234:235], v[230:231], v[230:231]
    v_rcp_f32 v232, v232
    v_rcp_f32 v233, v233
    v_rcp_f32 v234, v234
    v_rcp_f32 v235, v235
    v_pk_mul_f32 v[232:233], v[232:233], v[144:145]
    v_pk_mul_f32 v[234:235], v[234:235], v[146:147]
    v_cvt_pk_bf16_f32 v144, v232, v233
    v_cvt_pk_bf16_f32 v145, v234, v235
    v_pk_mul_f32 v[232:233], v[148:149], v[148:149]
    v_pk_mul_f32 v[234:235], v[150:151], v[150:151]
    buffer_load_dwordx4 v143, s[44:47], s83 offen offset:3072 lds
    v_pk_fma_f32 v[232:233], v[232:233], v[226:227], v[228:229]
    v_pk_fma_f32 v[234:235], v[234:235], v[226:227], v[228:229]
    v_pk_mul_f32 v[232:233], v[232:233], v[148:149]
    v_pk_mul_f32 v[234:235], v[234:235], v[150:151]
    v_exp_f32 v232, v232
    v_exp_f32 v233, v233
    v_exp_f32 v234, v234
    v_exp_f32 v235, v235
    v_pk_fma_f32 v[232:233], v[232:233], v[230:231], v[230:231]
    v_pk_fma_f32 v[234:235], v[234:235], v[230:231], v[230:231]
    v_rcp_f32 v232, v232
    s_add_u32 m0, s12, 116736
    s_add_u32 s39, s15, 48
    s_and_b32 s39, s39, 63
    s_mul_i32 s39, s39, 24576
    s_lshl_b32 s83, s7, 7
    s_add_u32 s83, s83, s39
    s_add_u32 s83, s83, 2048
    buffer_load_dwordx4 v6, s[44:47], s83 offen lds
    v_rcp_f32 v233, v233
    v_rcp_f32 v234, v234
    v_rcp_f32 v235, v235
    v_pk_mul_f32 v[232:233], v[232:233], v[148:149]
    v_pk_mul_f32 v[234:235], v[234:235], v[150:151]
    v_cvt_pk_bf16_f32 v146, v232, v233
    v_cvt_pk_bf16_f32 v147, v234, v235
    v_pk_mul_f32 v[232:233], v[152:153], v[152:153]
    v_pk_mul_f32 v[234:235], v[154:155], v[154:155]
    v_pk_fma_f32 v[232:233], v[232:233], v[226:227], v[228:229]
    v_pk_fma_f32 v[234:235], v[234:235], v[226:227], v[228:229]
    v_pk_mul_f32 v[232:233], v[232:233], v[152:153]
    v_pk_mul_f32 v[234:235], v[234:235], v[154:155]
    buffer_load_dwordx4 v141, s[44:47], s83 offen offset:1024 lds
    v_exp_f32 v232, v232
    v_exp_f32 v233, v233
    v_exp_f32 v234, v234
    v_exp_f32 v235, v235
    v_pk_fma_f32 v[232:233], v[232:233], v[230:231], v[230:231]
    v_pk_fma_f32 v[234:235], v[234:235], v[230:231], v[230:231]
    v_rcp_f32 v232, v232
    v_rcp_f32 v233, v233
    v_rcp_f32 v234, v234
    buffer_load_dwordx4 v142, s[44:47], s83 offen offset:2048 lds
    v_rcp_f32 v235, v235
    v_pk_mul_f32 v[232:233], v[232:233], v[152:153]
    v_pk_mul_f32 v[234:235], v[234:235], v[154:155]
    v_cvt_pk_bf16_f32 v148, v232, v233
    v_cvt_pk_bf16_f32 v149, v234, v235
    v_pk_mul_f32 v[232:233], v[156:157], v[156:157]
    v_pk_mul_f32 v[234:235], v[158:159], v[158:159]
    v_pk_fma_f32 v[232:233], v[232:233], v[226:227], v[228:229]
    v_pk_fma_f32 v[234:235], v[234:235], v[226:227], v[228:229]
    v_pk_mul_f32 v[232:233], v[232:233], v[156:157]
    v_pk_mul_f32 v[234:235], v[234:235], v[158:159]
    v_exp_f32 v232, v232
    v_exp_f32 v233, v233
    buffer_load_dwordx4 v143, s[44:47], s83 offen offset:3072 lds
    v_exp_f32 v234, v234
    v_exp_f32 v235, v235
    v_pk_fma_f32 v[232:233], v[232:233], v[230:231], v[230:231]
    v_pk_fma_f32 v[234:235], v[234:235], v[230:231], v[230:231]
    v_rcp_f32 v232, v232
    v_rcp_f32 v233, v233
    v_rcp_f32 v234, v234
    v_rcp_f32 v235, v235
    v_pk_mul_f32 v[232:233], v[232:233], v[156:157]
    v_pk_mul_f32 v[234:235], v[234:235], v[158:159]
    v_cvt_pk_bf16_f32 v150, v232, v233
    v_cvt_pk_bf16_f32 v151, v234, v235
    s_lshl_b32 s85, s20, 15
    s_lshl_b32 s86, s7, 12
    s_add_u32 s85, s85, s86
    s_lshl_b32 s86, s5, 11
    s_add_u32 s85, s85, s86
    s_add_u32 s85, s85, s19
    s_add_u32 s85, s85, 0
    buffer_store_dwordx4 v[144:147], v4, s[72:75], s85 offen sc1
    buffer_store_dwordx4 v[148:151], v4, s[72:75], s85 offen offset:1024 sc1
    s_mov_b64 s[94:95], exec
    v_lshlrev_b32 v250, 7, v1
L_lt_28:
    s_cmp_eq_u32 s3, 0
    s_cbranch_scc0 L_lt_29
    s_bfm_b64 exec, 16, 0
    s_mul_i32 s97, s2, 2048
    buffer_load_dword v255, v250, s[56:59], s97 offen
    s_bfm_b64 exec, 16, 0
    s_mul_i32 s97, s2, 2048
    buffer_load_dword v255, v250, s[48:51], s97 offen
    s_branch L_lte_27
L_lt_29:
    s_cmp_eq_u32 s3, 1
    s_cbranch_scc0 L_lt_30
    s_bfm_b64 exec, 22, 0
    s_mul_i32 s97, s2, 5504
    buffer_load_dword v255, v250, s[60:63], s97 offen
    s_bfm_b64 exec, 21, 0
    s_mul_i32 s97, s2, 5504
    s_add_u32 s97, s97, 2816
    buffer_load_dword v255, v250, s[60:63], s97 offen
    s_branch L_lte_27
L_lt_30:
    s_cmp_eq_u32 s3, 2
    s_cbranch_scc0 L_lt_31
    s_bfm_b64 exec, 22, 0
    s_mul_i32 s97, s2, 5504
    buffer_load_dword v255, v250, s[64:67], s97 offen
    s_bfm_b64 exec, 21, 0
    s_mul_i32 s97, s2, 5504
    s_add_u32 s97, s97, 2816
    buffer_load_dword v255, v250, s[64:67], s97 offen
    s_branch L_lte_27
L_lt_31:
    s_mov_b64 exec, 3
    v_lshlrev_b32 v250, 20, v1
    buffer_load_dword v255, v250, s[68:71], 0 offen
    s_mov_b64 exec, 1
    s_add_u32 s97, s19, 2031616
    buffer_load_dword v255, v246, s[72:75], s97 offen
L_lte_27:
    s_mov_b64 exec, s[94:95]
    v_add_u32 v232, 131072, v10
    v_mov_b32 v233, v10
    v_mov_b32 v206, 0
    v_mov_b32 v207, 0
    s_waitcnt vmcnt(20)
    s_barrier
    ds_read_b64_tr_b16 v[64:65], v232 offset:2048
    ds_read_b64_tr_b16 v[66:67], v232 offset:2560
    ds_read_b64_tr_b16 v[68:69], v232 offset:4096
    ds_read_b64_tr_b16 v[70:71], v232 offset:4608
    ds_read_b64_tr_b16 v[72:73], v232 offset:6144
    ds_read_b64_tr_b16 v[74:75], v232 offset:6656
    s_waitcnt lgkmcnt(4)
    v_mfma_f32_32x32x16_bf16 v[144:159], v[64:67], a[0:3], 0
    ds_read_b64_tr_b16 v[76:77], v232 offset:8192
    ds_read_b64_tr_b16 v[78:79], v232 offset:8704
    s_waitcnt lgkmcnt(4)
    v_mfma_f32_32x32x16_bf16 v[144:159], v[68:71], a[4:7], v[144:159]
    ds_read_b64_tr_b16 v[80:81], v232 offset:10240
    ds_read_b64_tr_b16 v[82:83], v232 offset:10752
    s_waitcnt lgkmcnt(4)
    v_mfma_f32_32x32x16_bf16 v[144:159], v[72:75], a[8:11], v[144:159]
    ds_read_b64_tr_b16 v[84:85], v232 offset:12288
    ds_read_b64_tr_b16 v[86:87], v232 offset:12800
    s_waitcnt lgkmcnt(4)
    v_mfma_f32_32x32x16_bf16 v[144:159], v[76:79], a[12:15], v[144:159]
    ds_read_b64_tr_b16 v[88:89], v232 offset:14336
    ds_read_b64_tr_b16 v[90:91], v232 offset:14848
    s_waitcnt lgkmcnt(4)
    v_mfma_f32_32x32x16_bf16 v[144:159], v[80:83], a[16:19], v[144:159]
    ds_read_b64_tr_b16 v[92:93], v232 offset:16384
    ds_read_b64_tr_b16 v[94:95], v232 offset:16896
    s_waitcnt lgkmcnt(4)
    v_mfma_f32_32x32x16_bf16 v[144:159], v[84:87], a[20:23], v[144:159]
    ds_read_b64_tr_b16 v[96:97], v233 offset:0
    ds_read_b64_tr_b16 v[98:99], v233 offset:512
    s_waitcnt lgkmcnt(4)
    v_mfma_f32_32x32x16_bf16 v[144:159], v[88:91], a[24:27], v[144:159]
    ds_read_b64_tr_b16 v[100:101], v233 offset:2048
    ds_read_b64_tr_b16 v[102:103], v233 offset:2560
    s_waitcnt lgkmcnt(4)
    v_mfma_f32_32x32x16_bf16 v[144:159], v[92:95], a[28:31], v[144:159]
    ds_read_b64_tr_b16 v[104:105], v233 offset:4096
    ds_read_b64_tr_b16 v[106:107], v233 offset:4608
    s_waitcnt lgkmcnt(4)
    v_mfma_f32_32x32x16_bf16 v[144:159], v[96:99], a[32:35], v[144:159]
    ds_read_b64_tr_b16 v[108:109], v233 offset:6144
    ds_read_b64_tr_b16 v[110:111], v233 offset:6656
    s_waitcnt lgkmcnt(4)
    v_mfma_f32_32x32x16_bf16 v[144:159], v[100:103], a[36:39], v[144:159]
    ds_read_b64_tr_b16 v[112:113], v233 offset:8192
    ds_read_b64_tr_b16 v[114:115], v233 offset:8704
    s_waitcnt lgkmcnt(4)
    v_mfma_f32_32x32x16_bf16 v[144:159], v[104:107], a[40:43], v[144:159]
    ds_read_b64_tr_b16 v[116:117], v233 offset:10240
    ds_read_b64_tr_b16 v[118:119], v233 offset:10752
    s_waitcnt lgkmcnt(4)
    v_mfma_f32_32x32x16_bf16 v[144:159], v[108:111], a[44:47], v[144:159]
    ds_read_b64_tr_b16 v[120:121], v233 offset:12288
    ds_read_b64_tr_b16 v[122:123], v233 offset:12800
    s_waitcnt lgkmcnt(4)
    v_mfma_f32_32x32x16_bf16 v[144:159], v[112:115], a[48:51], v[144:159]
    ds_read_b64_tr_b16 v[124:125], v233 offset:14336
    ds_read_b64_tr_b16 v[126:127], v233 offset:14848
    s_waitcnt lgkmcnt(4)
    v_mfma_f32_32x32x16_bf16 v[144:159], v[116:119], a[52:55], v[144:159]
    ds_read_b64_tr_b16 v[128:129], v233 offset:16384
    ds_read_b64_tr_b16 v[130:131], v233 offset:16896
    s_waitcnt lgkmcnt(4)
    v_mfma_f32_32x32x16_bf16 v[144:159], v[120:123], a[56:59], v[144:159]
    ds_read_b64_tr_b16 v[132:133], v233 offset:18432
    ds_read_b64_tr_b16 v[134:135], v233 offset:18944
    s_waitcnt lgkmcnt(4)
    v_mfma_f32_32x32x16_bf16 v[144:159], v[124:127], a[60:63], v[144:159]
    v_dot2c_f32_bf16 v206, s80, v64
    v_dot2c_f32_bf16 v207, s80, v65
    v_dot2c_f32_bf16 v206, s80, v66
    v_dot2c_f32_bf16 v207, s80, v67
    v_dot2c_f32_bf16 v206, s80, v68
    v_dot2c_f32_bf16 v207, s80, v69
    v_dot2c_f32_bf16 v206, s80, v70
    v_dot2c_f32_bf16 v207, s80, v71
    v_dot2c_f32_bf16 v206, s80, v72
    v_dot2c_f32_bf16 v207, s80, v73
    v_dot2c_f32_bf16 v206, s80, v74
    v_dot2c_f32_bf16 v207, s80, v75
    v_dot2c_f32_bf16 v206, s80, v76
    v_dot2c_f32_bf16 v207, s80, v77
    v_dot2c_f32_bf16 v206, s80, v78
    v_dot2c_f32_bf16 v207, s80, v79
    v_dot2c_f32_bf16 v206, s80, v80
    v_dot2c_f32_bf16 v207, s80, v81
    v_dot2c_f32_bf16 v206, s80, v82
    v_dot2c_f32_bf16 v207, s80, v83
    v_dot2c_f32_bf16 v206, s80, v84
    v_dot2c_f32_bf16 v207, s80, v85
    v_dot2c_f32_bf16 v206, s80, v86
    v_dot2c_f32_bf16 v207, s80, v87
    v_dot2c_f32_bf16 v206, s80, v88
    v_dot2c_f32_bf16 v207, s80, v89
    v_dot2c_f32_bf16 v206, s80, v90
    v_dot2c_f32_bf16 v207, s80, v91
    v_dot2c_f32_bf16 v206, s80, v92
    v_dot2c_f32_bf16 v207, s80, v93
    v_dot2c_f32_bf16 v206, s80, v94
    v_dot2c_f32_bf16 v207, s80, v95
    v_dot2c_f32_bf16 v206, s80, v96
    v_dot2c_f32_bf16 v207, s80, v97
    v_dot2c_f32_bf16 v206, s80, v98
    v_dot2c_f32_bf16 v207, s80, v99
    v_dot2c_f32_bf16 v206, s80, v100
    v_dot2c_f32_bf16 v207, s80, v101
    v_dot2c_f32_bf16 v206, s80, v102
    v_dot2c_f32_bf16 v207, s80, v103
    v_dot2c_f32_bf16 v206, s80, v104
    v_dot2c_f32_bf16 v207, s80, v105
    v_dot2c_f32_bf16 v206, s80, v106
    v_dot2c_f32_bf16 v207, s80, v107
    v_dot2c_f32_bf16 v206, s80, v108
    v_dot2c_f32_bf16 v207, s80, v109
    v_dot2c_f32_bf16 v206, s80, v110
    v_dot2c_f32_bf16 v207, s80, v111
    v_dot2c_f32_bf16 v206, s80, v112
    v_dot2c_f32_bf16 v207, s80, v113
    v_dot2c_f32_bf16 v206, s80, v114
    v_dot2c_f32_bf16 v207, s80, v115
    v_dot2c_f32_bf16 v206, s80, v116
    v_dot2c_f32_bf16 v207, s80, v117
    v_dot2c_f32_bf16 v206, s80, v118
    v_dot2c_f32_bf16 v207, s80, v119
    v_dot2c_f32_bf16 v206, s80, v120
    v_dot2c_f32_bf16 v207, s80, v121
    v_dot2c_f32_bf16 v206, s80, v122
    v_dot2c_f32_bf16 v207, s80, v123
    v_dot2c_f32_bf16 v206, s80, v124
    v_dot2c_f32_bf16 v207, s80, v125
    v_dot2c_f32_bf16 v206, s80, v126
    v_dot2c_f32_bf16 v207, s80, v127
    ds_read_b64_tr_b16 v[64:65], v233 offset:20480
    ds_read_b64_tr_b16 v[66:67], v233 offset:20992
    s_waitcnt lgkmcnt(4)
    v_mfma_f32_32x32x16_bf16 v[144:159], v[128:131], a[64:67], v[144:159]
    ds_read_b64_tr_b16 v[68:69], v233 offset:22528
    ds_read_b64_tr_b16 v[70:71], v233 offset:23040
    s_waitcnt lgkmcnt(4)
    v_mfma_f32_32x32x16_bf16 v[144:159], v[132:135], a[68:71], v[144:159]
    ds_read_b64_tr_b16 v[72:73], v233 offset:24576
    ds_read_b64_tr_b16 v[74:75], v233 offset:25088
    s_waitcnt lgkmcnt(4)
    v_mfma_f32_32x32x16_bf16 v[144:159], v[64:67], a[72:75], v[144:159]
    ds_read_b64_tr_b16 v[76:77], v233 offset:26624
    ds_read_b64_tr_b16 v[78:79], v233 offset:27136
    s_waitcnt lgkmcnt(4)
    v_mfma_f32_32x32x16_bf16 v[144:159], v[68:71], a[76:79], v[144:159]
    ds_read_b64_tr_b16 v[80:81], v233 offset:28672
    ds_read_b64_tr_b16 v[82:83], v233 offset:29184
    s_waitcnt lgkmcnt(4)
    v_mfma_f32_32x32x16_bf16 v[144:159], v[72:75], a[80:83], v[144:159]
    ds_read_b64_tr_b16 v[84:85], v233 offset:30720
    ds_read_b64_tr_b16 v[86:87], v233 offset:31232
    s_waitcnt lgkmcnt(4)
    v_mfma_f32_32x32x16_bf16 v[144:159], v[76:79], a[84:87], v[144:159]
    ds_read_b64_tr_b16 v[88:89], v233 offset:32768
    ds_read_b64_tr_b16 v[90:91], v233 offset:33280
    s_waitcnt lgkmcnt(4)
    v_mfma_f32_32x32x16_bf16 v[144:159], v[80:83], a[88:91], v[144:159]
    ds_read_b64_tr_b16 v[92:93], v233 offset:34816
    ds_read_b64_tr_b16 v[94:95], v233 offset:35328
    s_waitcnt lgkmcnt(4)
    v_mfma_f32_32x32x16_bf16 v[144:159], v[84:87], a[92:95], v[144:159]
    ds_read_b64_tr_b16 v[96:97], v233 offset:36864
    ds_read_b64_tr_b16 v[98:99], v233 offset:37376
    s_waitcnt lgkmcnt(4)
    v_mfma_f32_32x32x16_bf16 v[144:159], v[88:91], a[96:99], v[144:159]
    ds_read_b64_tr_b16 v[100:101], v233 offset:38912
    ds_read_b64_tr_b16 v[102:103], v233 offset:39424
    s_waitcnt lgkmcnt(4)
    v_mfma_f32_32x32x16_bf16 v[144:159], v[92:95], a[100:103], v[144:159]
    ds_read_b64_tr_b16 v[104:105], v233 offset:40960
    ds_read_b64_tr_b16 v[106:107], v233 offset:41472
    s_waitcnt lgkmcnt(4)
    v_mfma_f32_32x32x16_bf16 v[144:159], v[96:99], a[104:107], v[144:159]
    ds_read_b64_tr_b16 v[108:109], v233 offset:43008
    ds_read_b64_tr_b16 v[110:111], v233 offset:43520
    s_waitcnt lgkmcnt(4)
    v_mfma_f32_32x32x16_bf16 v[144:159], v[100:103], a[108:111], v[144:159]
    ds_read_b64_tr_b16 v[112:113], v233 offset:45056
    ds_read_b64_tr_b16 v[114:115], v233 offset:45568
    s_waitcnt lgkmcnt(4)
    v_mfma_f32_32x32x16_bf16 v[144:159], v[104:107], a[112:115], v[144:159]
    ds_read_b64_tr_b16 v[116:117], v233 offset:47104
    ds_read_b64_tr_b16 v[118:119], v233 offset:47616
    s_waitcnt lgkmcnt(4)
    v_mfma_f32_32x32x16_bf16 v[144:159], v[108:111], a[116:119], v[144:159]
    s_waitcnt lgkmcnt(2)
    v_mfma_f32_32x32x16_bf16 v[144:159], v[112:115], a[120:123], v[144:159]
    s_waitcnt lgkmcnt(0)
    v_mfma_f32_32x32x16_bf16 v[144:159], v[116:119], a[124:127], v[144:159]
    v_dot2c_f32_bf16 v206, s80, v128
    v_dot2c_f32_bf16 v207, s80, v129
    v_dot2c_f32_bf16 v206, s80, v130
    v_dot2c_f32_bf16 v207, s80, v131
    v_dot2c_f32_bf16 v206, s80, v132
    v_dot2c_f32_bf16 v207, s80, v133
    v_dot2c_f32_bf16 v206, s80, v134
    v_dot2c_f32_bf16 v207, s80, v135
    v_dot2c_f32_bf16 v206, s80, v64
    v_dot2c_f32_bf16 v207, s80, v65
    v_dot2c_f32_bf16 v206, s80, v66
    v_dot2c_f32_bf16 v207, s80, v67
    v_dot2c_f32_bf16 v206, s80, v68
    v_dot2c_f32_bf16 v207, s80, v69
    v_dot2c_f32_bf16 v206, s80, v70
    v_dot2c_f32_bf16 v207, s80, v71
    v_dot2c_f32_bf16 v206, s80, v72
    v_dot2c_f32_bf16 v207, s80, v73
    v_dot2c_f32_bf16 v206, s80, v74
    v_dot2c_f32_bf16 v207, s80, v75
    v_dot2c_f32_bf16 v206, s80, v76
    v_dot2c_f32_bf16 v207, s80, v77
    v_dot2c_f32_bf16 v206, s80, v78
    v_dot2c_f32_bf16 v207, s80, v79
    v_dot2c_f32_bf16 v206, s80, v80
    v_dot2c_f32_bf16 v207, s80, v81
    v_dot2c_f32_bf16 v206, s80, v82
    v_dot2c_f32_bf16 v207, s80, v83
    v_dot2c_f32_bf16 v206, s80, v84
    v_dot2c_f32_bf16 v207, s80, v85
    v_dot2c_f32_bf16 v206, s80, v86
    v_dot2c_f32_bf16 v207, s80, v87
    v_dot2c_f32_bf16 v206, s80, v88
    v_dot2c_f32_bf16 v207, s80, v89
    v_dot2c_f32_bf16 v206, s80, v90
    v_dot2c_f32_bf16 v207, s80, v91
    v_dot2c_f32_bf16 v206, s80, v92
    v_dot2c_f32_bf16 v207, s80, v93
    v_dot2c_f32_bf16 v206, s80, v94
    v_dot2c_f32_bf16 v207, s80, v95
    v_dot2c_f32_bf16 v206, s80, v96
    v_dot2c_f32_bf16 v207, s80, v97
    v_dot2c_f32_bf16 v206, s80, v98
    v_dot2c_f32_bf16 v207, s80, v99
    v_dot2c_f32_bf16 v206, s80, v100
    v_dot2c_f32_bf16 v207, s80, v101
    v_dot2c_f32_bf16 v206, s80, v102
    v_dot2c_f32_bf16 v207, s80, v103
    v_dot2c_f32_bf16 v206, s80, v104
    v_dot2c_f32_bf16 v207, s80, v105
    v_dot2c_f32_bf16 v206, s80, v106
    v_dot2c_f32_bf16 v207, s80, v107
    v_dot2c_f32_bf16 v206, s80, v108
    v_dot2c_f32_bf16 v207, s80, v109
    v_dot2c_f32_bf16 v206, s80, v110
    v_dot2c_f32_bf16 v207, s80, v111
    v_dot2c_f32_bf16 v206, s80, v112
    v_dot2c_f32_bf16 v207, s80, v113
    v_dot2c_f32_bf16 v206, s80, v114
    v_dot2c_f32_bf16 v207, s80, v115
    v_dot2c_f32_bf16 v206, s80, v116
    v_dot2c_f32_bf16 v207, s80, v117
    v_dot2c_f32_bf16 v206, s80, v118
    v_dot2c_f32_bf16 v207, s80, v119
    s_waitcnt vmcnt(2)
    s_barrier
    s_cmp_lg_u32 s3, 3
    s_cbranch_scc1 L_askip_32
    s_mov_b64 s[94:95], exec
    s_mov_b64 exec, 1
    s_mov_b32 s91, 400000
    s_branch L_ichk_35
L_iloop_33:
    buffer_load_dword v247, v246, s[76:79], 0 offen sc1
    s_waitcnt vmcnt(0)
L_ichk_35:
    v_cmp_eq_u32 vcc, 1, v247
    s_sub_u32 s91, s91, 1
    s_cbranch_scc1 L_idone_34
    s_cmp_eq_u64 vcc, exec
    s_cbranch_scc0 L_iloop_33
L_idone_34:
    s_and_b32 s97, s6, 3
    s_lshl_b32 s97, s97, 8
    s_add_u32 s97, s97, s19
    s_add_u32 s97, s97, 1703936
    v_mov_b32 v248, s97
    v_mov_b32 v249, 1
    buffer_atomic_add v249, v248, s[72:75], 0 offen
    s_mov_b64 exec, s[94:95]
L_askip_32:
    v_cmp_gt_u32 vcc, 32, v1
    s_nop 1
    v_add_f32 v206, v206, v207
    v_mov_b32 v225, v206
    s_nop 1
    v_permlane32_swap_b32 v206, v225
    s_nop 0
    v_add_f32 v206, v206, v225
    v_cndmask_b32 v206, 0, v206, vcc
    s_nop 1
    v_mfma_f32_32x32x2_f32 v[144:159], v206, v14, v[144:159]
    s_add_u32 m0, s12, 0
    s_add_u32 s83, s27, 0
    buffer_load_dwordx4 v5, s[56:59], s83 offen lds
    buffer_load_dwordx4 v136, s[56:59], s83 offen offset:1024 lds
    buffer_load_dwordx4 v137, s[56:59], s83 offen offset:2048 lds
    s_nop 12
    v_mul_f32 v144, v15, v144
    buffer_load_dwordx4 v138, s[56:59], s83 offen offset:3072 lds
    v_mul_f32 v145, v15, v145
    v_cvt_pk_bf16_f32 v40, v144, v145
    v_mul_f32 v146, v15, v146
    v_mul_f32 v147, v15, v147
    v_cvt_pk_bf16_f32 v41, v146, v147
    v_mul_f32 v148, v15, v148
    v_mul_f32 v149, v15, v149
    v_cvt_pk_bf16_f32 v42, v148, v149
    v_mul_f32 v150, v15, v150
    v_mul_f32 v151, v15, v151
    v_cvt_pk_bf16_f32 v43, v150, v151
    v_mul_f32 v152, v15, v152
    v_mul_f32 v153, v15, v153
    v_cvt_pk_bf16_f32 v44, v152, v153
    v_mul_f32 v154, v15, v154
    v_mul_f32 v155, v15, v155
    s_add_u32 m0, s12, 16384
    s_add_u32 s83, s27, 131072
    buffer_load_dwordx4 v5, s[56:59], s83 offen lds
    v_cvt_pk_bf16_f32 v45, v154, v155
    v_mul_f32 v156, v15, v156
    v_mul_f32 v157, v15, v157
    v_cvt_pk_bf16_f32 v46, v156, v157
    v_mul_f32 v158, v15, v158
    v_mul_f32 v159, v15, v159
    v_cvt_pk_bf16_f32 v47, v158, v159
    s_nop 1
    v_permlane32_swap_b32 v40, v44
    v_permlane32_swap_b32 v41, v45
    v_permlane32_swap_b32 v42, v46
    v_permlane32_swap_b32 v43, v47
    s_lshl_b32 s85, s6, 6
    s_lshl_b32 s86, s4, 5
    s_add_u32 s85, s85, s86
    s_add_u32 s86, s5, 1
    v_add_u32 v192, s85, v2
    v_subrev_u32 v192, s86, v192
    v_lshrrev_b32 v193, 8, v192
    v_lshlrev_b32 v193, 21, v193
    v_bfe_u32 v194, v192, 5, 3
    v_lshl_add_u32 v193, v194, 15, v193
    v_and_b32 v194, 31, v192
    v_lshl_add_u32 v193, v194, 4, v193
    v_lshl_add_u32 v193, v3, 9, v193
    v_mov_b32 v194, 0x80000000
    s_movk_i32 s87, 2048
    v_cmp_gt_u32 vcc, s87, v192
    s_nop 1
    v_cndmask_b32 v242, v194, v193, vcc
    v_add_u32 v192, s85, v2
    v_add_u32 v192, s86, v192
    v_lshrrev_b32 v193, 8, v192
    v_lshlrev_b32 v193, 21, v193
    v_bfe_u32 v194, v192, 5, 3
    v_lshl_add_u32 v193, v194, 15, v193
    v_and_b32 v194, 31, v192
    v_lshl_add_u32 v193, v194, 4, v193
    v_lshl_add_u32 v193, v3, 9, v193
    v_mov_b32 v194, 0x80000000
    s_movk_i32 s87, 2048
    v_cmp_gt_u32 vcc, s87, v192
    s_nop 1
    v_cndmask_b32 v243, v194, v193, vcc
    s_lshl_b32 s85, s5, 15
    v_add_u32 v244, s85, v11
    v_add_u32 v245, s85, v12
    v_add_u32 v232, 65536, v10
    v_add_u32 v233, 131072, v10
    v_mov_b32 v206, 0
    v_mov_b32 v207, 0
    s_waitcnt vmcnt(9)
    s_barrier
    ds_read_b64_tr_b16 v[64:65], v232 offset:2048
    ds_read_b64_tr_b16 v[66:67], v232 offset:2560
    ds_read_b64_tr_b16 v[68:69], v232 offset:4096
    ds_read_b64_tr_b16 v[70:71], v232 offset:4608
    ds_read_b64_tr_b16 v[72:73], v232 offset:6144
    ds_read_b64_tr_b16 v[74:75], v232 offset:6656
    s_waitcnt lgkmcnt(4)
    v_mfma_f32_32x32x16_bf16 v[144:159], v[64:67], a[0:3], 0
    ds_read_b64_tr_b16 v[76:77], v232 offset:8192
    ds_read_b64_tr_b16 v[78:79], v232 offset:8704
    s_waitcnt lgkmcnt(4)
    v_mfma_f32_32x32x16_bf16 v[144:159], v[68:71], a[4:7], v[144:159]
    buffer_load_dwordx4 v136, s[56:59], s83 offen offset:1024 lds
    ds_read_b64_tr_b16 v[80:81], v232 offset:10240
    ds_read_b64_tr_b16 v[82:83], v232 offset:10752
    s_waitcnt lgkmcnt(4)
    v_mfma_f32_32x32x16_bf16 v[144:159], v[72:75], a[8:11], v[144:159]
    ds_read_b64_tr_b16 v[84:85], v232 offset:12288
    ds_read_b64_tr_b16 v[86:87], v232 offset:12800
    s_waitcnt lgkmcnt(4)
    v_mfma_f32_32x32x16_bf16 v[144:159], v[76:79], a[12:15], v[144:159]
    buffer_load_dwordx4 v137, s[56:59], s83 offen offset:2048 lds
    ds_read_b64_tr_b16 v[88:89], v232 offset:14336
    ds_read_b64_tr_b16 v[90:91], v232 offset:14848
    s_waitcnt lgkmcnt(4)
    v_mfma_f32_32x32x16_bf16 v[144:159], v[80:83], a[16:19], v[144:159]
    ds_read_b64_tr_b16 v[92:93], v232 offset:16384
    ds_read_b64_tr_b16 v[94:95], v232 offset:16896
    s_waitcnt lgkmcnt(4)
    v_mfma_f32_32x32x16_bf16 v[144:159], v[84:87], a[20:23], v[144:159]
    buffer_load_dwordx4 v138, s[56:59], s83 offen offset:3072 lds
    ds_read_b64_tr_b16 v[96:97], v232 offset:18432
    ds_read_b64_tr_b16 v[98:99], v232 offset:18944
    s_waitcnt lgkmcnt(4)
    v_mfma_f32_32x32x16_bf16 v[144:159], v[88:91], a[24:27], v[144:159]
    ds_read_b64_tr_b16 v[100:101], v232 offset:20480
    ds_read_b64_tr_b16 v[102:103], v232 offset:20992
    s_waitcnt lgkmcnt(4)
    v_mfma_f32_32x32x16_bf16 v[144:159], v[92:95], a[28:31], v[144:159]
    s_add_u32 m0, s12, 32768
    s_add_u32 s83, s27, 262144
    buffer_load_dwordx4 v5, s[56:59], s83 offen lds
    ds_read_b64_tr_b16 v[104:105], v232 offset:22528
    ds_read_b64_tr_b16 v[106:107], v232 offset:23040
    s_waitcnt lgkmcnt(4)
    v_mfma_f32_32x32x16_bf16 v[144:159], v[96:99], a[32:35], v[144:159]
    ds_read_b64_tr_b16 v[108:109], v232 offset:24576
    ds_read_b64_tr_b16 v[110:111], v232 offset:25088
    s_waitcnt lgkmcnt(4)
    v_mfma_f32_32x32x16_bf16 v[144:159], v[100:103], a[36:39], v[144:159]
    buffer_load_dwordx4 v136, s[56:59], s83 offen offset:1024 lds
    ds_read_b64_tr_b16 v[112:113], v232 offset:26624
    ds_read_b64_tr_b16 v[114:115], v232 offset:27136
    s_waitcnt lgkmcnt(4)
    v_mfma_f32_32x32x16_bf16 v[144:159], v[104:107], a[40:43], v[144:159]
    ds_read_b64_tr_b16 v[116:117], v232 offset:28672
    ds_read_b64_tr_b16 v[118:119], v232 offset:29184
    s_waitcnt lgkmcnt(4)
    v_mfma_f32_32x32x16_bf16 v[144:159], v[108:111], a[44:47], v[144:159]
    buffer_load_dwordx4 v137, s[56:59], s83 offen offset:2048 lds
    ds_read_b64_tr_b16 v[120:121], v232 offset:30720
    ds_read_b64_tr_b16 v[122:123], v232 offset:31232
    s_waitcnt lgkmcnt(4)
    v_mfma_f32_32x32x16_bf16 v[144:159], v[112:115], a[48:51], v[144:159]
    ds_read_b64_tr_b16 v[124:125], v232 offset:32768
    ds_read_b64_tr_b16 v[126:127], v232 offset:33280
    s_waitcnt lgkmcnt(4)
    v_mfma_f32_32x32x16_bf16 v[144:159], v[116:119], a[52:55], v[144:159]
    buffer_load_dwordx4 v138, s[56:59], s83 offen offset:3072 lds
    ds_read_b64_tr_b16 v[128:129], v232 offset:34816
    ds_read_b64_tr_b16 v[130:131], v232 offset:35328
    s_waitcnt lgkmcnt(4)
    v_mfma_f32_32x32x16_bf16 v[144:159], v[120:123], a[56:59], v[144:159]
    ds_read_b64_tr_b16 v[132:133], v232 offset:36864
    ds_read_b64_tr_b16 v[134:135], v232 offset:37376
    s_waitcnt lgkmcnt(4)
    v_mfma_f32_32x32x16_bf16 v[144:159], v[124:127], a[60:63], v[144:159]
    s_add_u32 m0, s12, 49152
    s_add_u32 s83, s27, 393216
    buffer_load_dwordx4 v5, s[56:59], s83 offen lds
    v_dot2c_f32_bf16 v206, s80, v64
    v_dot2c_f32_bf16 v207, s80, v65
    v_dot2c_f32_bf16 v206, s80, v66
    v_dot2c_f32_bf16 v207, s80, v67
    v_dot2c_f32_bf16 v206, s80, v68
    v_dot2c_f32_bf16 v207, s80, v69
    v_dot2c_f32_bf16 v206, s80, v70
    v_dot2c_f32_bf16 v207, s80, v71
    v_dot2c_f32_bf16 v206, s80, v72
    v_dot2c_f32_bf16 v207, s80, v73
    v_dot2c_f32_bf16 v206, s80, v74
    v_dot2c_f32_bf16 v207, s80, v75
    buffer_load_dwordx4 v136, s[56:59], s83 offen offset:1024 lds
    v_dot2c_f32_bf16 v206, s80, v76
    v_dot2c_f32_bf16 v207, s80, v77
    v_dot2c_f32_bf16 v206, s80, v78
    v_dot2c_f32_bf16 v207, s80, v79
    v_dot2c_f32_bf16 v206, s80, v80
    v_dot2c_f32_bf16 v207, s80, v81
    v_dot2c_f32_bf16 v206, s80, v82
    v_dot2c_f32_bf16 v207, s80, v83
    v_dot2c_f32_bf16 v206, s80, v84
    v_dot2c_f32_bf16 v207, s80, v85
    v_dot2c_f32_bf16 v206, s80, v86
    v_dot2c_f32_bf16 v207, s80, v87
    v_dot2c_f32_bf16 v206, s80, v88
    v_dot2c_f32_bf16 v207, s80, v89
    v_dot2c_f32_bf16 v206, s80, v90
    v_dot2c_f32_bf16 v207, s80, v91
    buffer_load_dwordx4 v137, s[56:59], s83 offen offset:2048 lds
    v_dot2c_f32_bf16 v206, s80, v92
    v_dot2c_f32_bf16 v207, s80, v93
    v_dot2c_f32_bf16 v206, s80, v94
    v_dot2c_f32_bf16 v207, s80, v95
    v_dot2c_f32_bf16 v206, s80, v96
    v_dot2c_f32_bf16 v207, s80, v97
    v_dot2c_f32_bf16 v206, s80, v98
    v_dot2c_f32_bf16 v207, s80, v99
    v_dot2c_f32_bf16 v206, s80, v100
    v_dot2c_f32_bf16 v207, s80, v101
    v_dot2c_f32_bf16 v206, s80, v102
    v_dot2c_f32_bf16 v207, s80, v103
    buffer_load_dwordx4 v138, s[56:59], s83 offen offset:3072 lds
    v_dot2c_f32_bf16 v206, s80, v104
    v_dot2c_f32_bf16 v207, s80, v105
    v_dot2c_f32_bf16 v206, s80, v106
    v_dot2c_f32_bf16 v207, s80, v107
    v_dot2c_f32_bf16 v206, s80, v108
    v_dot2c_f32_bf16 v207, s80, v109
    v_dot2c_f32_bf16 v206, s80, v110
    v_dot2c_f32_bf16 v207, s80, v111
    v_dot2c_f32_bf16 v206, s80, v112
    v_dot2c_f32_bf16 v207, s80, v113
    v_dot2c_f32_bf16 v206, s80, v114
    v_dot2c_f32_bf16 v207, s80, v115
    v_dot2c_f32_bf16 v206, s80, v116
    v_dot2c_f32_bf16 v207, s80, v117
    v_dot2c_f32_bf16 v206, s80, v118
    v_dot2c_f32_bf16 v207, s80, v119
    v_dot2c_f32_bf16 v206, s80, v120
    v_dot2c_f32_bf16 v207, s80, v121
    v_dot2c_f32_bf16 v206, s80, v122
    v_dot2c_f32_bf16 v207, s80, v123
    v_dot2c_f32_bf16 v206, s80, v124
    v_dot2c_f32_bf16 v207, s80, v125
    v_dot2c_f32_bf16 v206, s80, v126
    v_dot2c_f32_bf16 v207, s80, v127
    s_add_u32 m0, s32, 133120
    s_add_u32 s39, s3, 0
    s_mul_i32 s39, s39, 44032
    s_lshl_b32 s92, s89, 6
    s_add_u32 s83, s39, s92
    buffer_load_dwordx4 v7, s[60:63], s83 offen lds
    ds_read_b64_tr_b16 v[64:65], v232 offset:38912
    ds_read_b64_tr_b16 v[66:67], v232 offset:39424
    s_waitcnt lgkmcnt(4)
    v_mfma_f32_32x32x16_bf16 v[144:159], v[128:131], a[64:67], v[144:159]
    ds_read_b64_tr_b16 v[68:69], v232 offset:40960
    ds_read_b64_tr_b16 v[70:71], v232 offset:41472
    s_waitcnt lgkmcnt(4)
    v_mfma_f32_32x32x16_bf16 v[144:159], v[132:135], a[68:71], v[144:159]
    ds_read_b64_tr_b16 v[72:73], v232 offset:43008
    ds_read_b64_tr_b16 v[74:75], v232 offset:43520
    s_waitcnt lgkmcnt(4)
    v_mfma_f32_32x32x16_bf16 v[144:159], v[64:67], a[72:75], v[144:159]
    buffer_load_dwordx4 v8, s[60:63], s83 offen offset:1024 lds
    ds_read_b64_tr_b16 v[76:77], v232 offset:45056
    ds_read_b64_tr_b16 v[78:79], v232 offset:45568
    s_waitcnt lgkmcnt(4)
    v_mfma_f32_32x32x16_bf16 v[144:159], v[68:71], a[76:79], v[144:159]
    ds_read_b64_tr_b16 v[80:81], v232 offset:47104
    ds_read_b64_tr_b16 v[82:83], v232 offset:47616
    s_waitcnt lgkmcnt(4)
    v_mfma_f32_32x32x16_bf16 v[144:159], v[72:75], a[80:83], v[144:159]
    ds_read_b64_tr_b16 v[84:85], v232 offset:49152
    ds_read_b64_tr_b16 v[86:87], v232 offset:49664
    s_waitcnt lgkmcnt(4)
    v_mfma_f32_32x32x16_bf16 v[144:159], v[76:79], a[84:87], v[144:159]
    buffer_load_dwordx4 v9, s[60:63], s83 offen offset:2048 lds
    ds_read_b64_tr_b16 v[88:89], v232 offset:51200
    ds_read_b64_tr_b16 v[90:91], v232 offset:51712
    s_waitcnt lgkmcnt(4)
    v_mfma_f32_32x32x16_bf16 v[144:159], v[80:83], a[88:91], v[144:159]
    ds_read_b64_tr_b16 v[92:93], v232 offset:53248
    ds_read_b64_tr_b16 v[94:95], v232 offset:53760
    s_waitcnt lgkmcnt(4)
    v_mfma_f32_32x32x16_bf16 v[144:159], v[84:87], a[92:95], v[144:159]
    ds_read_b64_tr_b16 v[96:97], v232 offset:55296
    ds_read_b64_tr_b16 v[98:99], v232 offset:55808
    s_waitcnt lgkmcnt(4)
    v_mfma_f32_32x32x16_bf16 v[144:159], v[88:91], a[96:99], v[144:159]
    s_add_u32 m0, m0, 12288
    s_add_u32 s83, s83, 176128
    buffer_load_dwordx4 v7, s[60:63], s83 offen lds
    ds_read_b64_tr_b16 v[100:101], v232 offset:57344
    ds_read_b64_tr_b16 v[102:103], v232 offset:57856
    s_waitcnt lgkmcnt(4)
    v_mfma_f32_32x32x16_bf16 v[144:159], v[92:95], a[100:103], v[144:159]
    ds_read_b64_tr_b16 v[104:105], v232 offset:59392
    ds_read_b64_tr_b16 v[106:107], v232 offset:59904
    s_waitcnt lgkmcnt(4)
    v_mfma_f32_32x32x16_bf16 v[144:159], v[96:99], a[104:107], v[144:159]
    s_cmp_lg_u32 s3, 3
    s_cbranch_scc1 L_piskip_36
    s_add_u32 s97, s6, -1
    v_add_u32 v250, s97, v1
    v_max_i32 v250, 0, v250
    v_min_i32 v250, 31, v250
    v_lshrrev_b32 v251, 2, v250
    v_lshlrev_b32 v251, 21, v251
    v_and_b32 v250, 3, v250
    v_lshl_add_u32 v250, v250, 8, v251
    v_add_u32 v250, 1703936, v250
    v_mov_b32 v251, 8
    s_mov_b64 s[94:95], exec
    s_mov_b64 exec, 7
    buffer_load_dword v252, v250, s[72:75], 0 offen sc1
    s_mov_b64 exec, s[94:95]
L_piskip_36:
    ds_read_b64_tr_b16 v[108:109], v232 offset:61440
    ds_read_b64_tr_b16 v[110:111], v232 offset:61952
    s_waitcnt lgkmcnt(4)
    v_mfma_f32_32x32x16_bf16 v[144:159], v[100:103], a[108:111], v[144:159]
    buffer_load_dwordx4 v8, s[60:63], s83 offen offset:1024 lds
    ds_read_b64_tr_b16 v[112:113], v232 offset:63488
    ds_read_b64_tr_b16 v[114:115], v232 offset:64000
    s_waitcnt lgkmcnt(4)
    v_mfma_f32_32x32x16_bf16 v[144:159], v[104:107], a[112:115], v[144:159]
    ds_read_b64_tr_b16 v[116:117], v233 offset:0
    ds_read_b64_tr_b16 v[118:119], v233 offset:512
    s_waitcnt lgkmcnt(4)
    v_mfma_f32_32x32x16_bf16 v[144:159], v[108:111], a[116:119], v[144:159]
    s_waitcnt lgkmcnt(2)
    v_mfma_f32_32x32x16_bf16 v[144:159], v[112:115], a[120:123], v[144:159]
    buffer_load_dwordx4 v9, s[60:63], s83 offen offset:2048 lds
    s_waitcnt lgkmcnt(0)
    v_mfma_f32_32x32x16_bf16 v[144:159], v[116:119], a[124:127], v[144:159]
    v_dot2c_f32_bf16 v206, s80, v128
    v_dot2c_f32_bf16 v207, s80, v129
    v_dot2c_f32_bf16 v206, s80, v130
    v_dot2c_f32_bf16 v207, s80, v131
    v_dot2c_f32_bf16 v206, s80, v132
    v_dot2c_f32_bf16 v207, s80, v133
    v_dot2c_f32_bf16 v206, s80, v134
    v_dot2c_f32_bf16 v207, s80, v135
    s_add_u32 s92, s3, 0
    s_min_u32 s92, s92, 1
    s_mul_i32 s39, s92, 3072
    s_add_u32 m0, s39, 157696
    s_add_u32 s39, s92, 30
    s_mul_i32 s39, s39, 44032
    s_lshl_b32 s92, s89, 6
    s_add_u32 s83, s39, s92
    buffer_load_dwordx4 v7, s[60:63], s83 offen lds
    v_dot2c_f32_bf16 v206, s80, v64
    v_dot2c_f32_bf16 v207, s80, v65
    v_dot2c_f32_bf16 v206, s80, v66
    v_dot2c_f32_bf16 v207, s80, v67
    v_dot2c_f32_bf16 v206, s80, v68
    v_dot2c_f32_bf16 v207, s80, v69
    v_dot2c_f32_bf16 v206, s80, v70
    v_dot2c_f32_bf16 v207, s80, v71
    v_dot2c_f32_bf16 v206, s80, v72
    v_dot2c_f32_bf16 v207, s80, v73
    v_dot2c_f32_bf16 v206, s80, v74
    v_dot2c_f32_bf16 v207, s80, v75
    v_dot2c_f32_bf16 v206, s80, v76
    v_dot2c_f32_bf16 v207, s80, v77
    v_dot2c_f32_bf16 v206, s80, v78
    v_dot2c_f32_bf16 v207, s80, v79
    v_dot2c_f32_bf16 v206, s80, v80
    v_dot2c_f32_bf16 v207, s80, v81
    v_dot2c_f32_bf16 v206, s80, v82
    v_dot2c_f32_bf16 v207, s80, v83
    v_dot2c_f32_bf16 v206, s80, v84
    v_dot2c_f32_bf16 v207, s80, v85
    v_dot2c_f32_bf16 v206, s80, v86
    v_dot2c_f32_bf16 v207, s80, v87
    buffer_load_dwordx4 v8, s[60:63], s83 offen offset:1024 lds
    v_dot2c_f32_bf16 v206, s80, v88
    v_dot2c_f32_bf16 v207, s80, v89
    v_dot2c_f32_bf16 v206, s80, v90
    v_dot2c_f32_bf16 v207, s80, v91
    v_dot2c_f32_bf16 v206, s80, v92
    v_dot2c_f32_bf16 v207, s80, v93
    v_dot2c_f32_bf16 v206, s80, v94
    v_dot2c_f32_bf16 v207, s80, v95
    v_dot2c_f32_bf16 v206, s80, v96
    v_dot2c_f32_bf16 v207, s80, v97
    v_dot2c_f32_bf16 v206, s80, v98
    v_dot2c_f32_bf16 v207, s80, v99
    v_dot2c_f32_bf16 v206, s80, v100
    v_dot2c_f32_bf16 v207, s80, v101
    v_dot2c_f32_bf16 v206, s80, v102
    v_dot2c_f32_bf16 v207, s80, v103
    v_dot2c_f32_bf16 v206, s80, v104
    v_dot2c_f32_bf16 v207, s80, v105
    v_dot2c_f32_bf16 v206, s80, v106
    v_dot2c_f32_bf16 v207, s80, v107
    buffer_load_dwordx4 v9, s[60:63], s83 offen offset:2048 lds
    v_dot2c_f32_bf16 v206, s80, v108
    v_dot2c_f32_bf16 v207, s80, v109
    v_dot2c_f32_bf16 v206, s80, v110
    v_dot2c_f32_bf16 v207, s80, v111
    v_dot2c_f32_bf16 v206, s80, v112
    v_dot2c_f32_bf16 v207, s80, v113
    v_dot2c_f32_bf16 v206, s80, v114
    v_dot2c_f32_bf16 v207, s80, v115
    v_dot2c_f32_bf16 v206, s80, v116
    v_dot2c_f32_bf16 v207, s80, v117
    v_dot2c_f32_bf16 v206, s80, v118
    v_dot2c_f32_bf16 v207, s80, v119
    s_lshl_b32 s35, s5, 14
    s_add_u32 s35, s35, 0
    s_add_u32 s36, s35, 8192
    s_lshl_b32 s88, s37, 10
    s_add_u32 s88, s88, s35
    s_waitcnt vmcnt(9)
    s_cmp_lg_u32 s3, 3
    s_cbranch_scc1 L_pskip_37
    s_mov_b64 s[94:95], exec
    s_mov_b64 exec, 7
    s_mov_b32 s91, 400000
    s_waitcnt vmcnt(5)
    s_branch L_pchk_40
L_ploop_38:
    buffer_load_dword v252, v250, s[72:75], 0 offen sc1
    s_waitcnt vmcnt(0)
L_pchk_40:
    v_cmp_ge_u32 vcc, v252, v251
    s_sub_u32 s91, s91, 1
    s_cbranch_scc1 L_pdone_39
    s_cmp_eq_u64 vcc, exec
    s_cbranch_scc0 L_ploop_38
L_pdone_39:
    s_mov_b64 exec, s[94:95]
L_pskip_37:
    s_barrier
    buffer_load_dwordx4 a[128:131], v242, s[72:75], s88 offen offset:0 sc1
    buffer_load_dwordx4 a[132:135], v242, s[72:75], s88 offen offset:1024 sc1
    v_cmp_gt_u32 vcc, 32, v1
    s_nop 1
    v_add_f32 v206, v206, v207
    v_mov_b32 v225, v206
    s_nop 1
    v_permlane32_swap_b32 v206, v225
    s_nop 0
    v_add_f32 v206, v206, v225
    buffer_load_dwordx4 a[136:139], v242, s[72:75], s88 offen offset:2048 sc1
    v_cndmask_b32 v206, 0, v206, vcc
    s_nop 1
    v_mfma_f32_32x32x2_f32 v[144:159], v206, v14, v[144:159]
    buffer_load_dwordx4 a[140:143], v242, s[72:75], s88 offen offset:3072 sc1
    s_add_u32 s88, s88, 4096
    buffer_load_dwordx4 a[144:147], v242, s[72:75], s88 offen offset:0 sc1
    buffer_load_dwordx4 a[148:151], v242, s[72:75], s88 offen offset:1024 sc1
    s_nop 13
    v_mul_f32 v144, v15, v144
    v_mul_f32 v145, v15, v145
    v_cvt_pk_bf16_f32 v48, v144, v145
    v_mul_f32 v146, v15, v146
    v_mul_f32 v147, v15, v147
    buffer_load_dwordx4 a[152:155], v242, s[72:75], s88 offen offset:2048 sc1
    v_cvt_pk_bf16_f32 v49, v146, v147
    v_mul_f32 v148, v15, v148
    v_mul_f32 v149, v15, v149
    v_cvt_pk_bf16_f32 v50, v148, v149
    v_mul_f32 v150, v15, v150
    v_mul_f32 v151, v15, v151
    v_cvt_pk_bf16_f32 v51, v150, v151
    v_mul_f32 v152, v15, v152
    v_mul_f32 v153, v15, v153
    v_cvt_pk_bf16_f32 v52, v152, v153
    v_mul_f32 v154, v15, v154
    v_mul_f32 v155, v15, v155
    v_cvt_pk_bf16_f32 v53, v154, v155
    v_mul_f32 v156, v15, v156
    v_mul_f32 v157, v15, v157
    v_cvt_pk_bf16_f32 v54, v156, v157
    buffer_load_dwordx4 a[156:159], v242, s[72:75], s88 offen offset:3072 sc1
    v_mul_f32 v158, v15, v158
    v_mul_f32 v159, v15, v159
    v_cvt_pk_bf16_f32 v55, v158, v159
    s_nop 1
    v_permlane32_swap_b32 v48, v52
    v_permlane32_swap_b32 v49, v53
    v_permlane32_swap_b32 v50, v54
    v_permlane32_swap_b32 v51, v55
    s_cmp_lg_u32 s4, 1
    s_cbranch_scc1 L_halo_41
    s_and_b32 s85, s6, 3
    s_lshl_b32 s85, s85, 3
    s_add_u32 s85, s85, s7
    s_lshl_b32 s85, s85, 12
    s_lshl_b32 s86, s5, 10
    s_add_u32 s85, s85, s86
    s_add_u32 s85, s85, s19
    s_add_u32 s85, s85, 1572864
    v_subrev_u32 v192, 16, v2
    v_lshlrev_b32 v192, 4, v192
    v_lshl_add_u32 v192, v3, 9, v192
    v_cmp_le_u32 vcc, 16, v2
    s_and_saveexec_b64 s[94:95], vcc
    buffer_store_dwordx4 v[40:43], v192, s[72:75], s85 offen sc1
    buffer_store_dwordx4 v[44:47], v192, s[72:75], s85 offen offset:256 sc1
    buffer_store_dwordx4 v[48:51], v192, s[72:75], s85 offen offset:2048 sc1
    buffer_store_dwordx4 v[52:55], v192, s[72:75], s85 offen offset:2304 sc1
    s_mov_b64 exec, s[94:95]
L_halo_41:
    ds_read_b64_tr_b16 v[64:65], v244 offset:0
    ds_read_b64_tr_b16 v[66:67], v244 offset:1024
    ds_read_b64_tr_b16 v[68:69], v245 offset:0
    ds_read_b64_tr_b16 v[70:71], v245 offset:1024
    ds_read_b64_tr_b16 v[72:73], v244 offset:2048
    ds_read_b64_tr_b16 v[74:75], v244 offset:3072
    ds_read_b64_tr_b16 v[76:77], v245 offset:2048
    ds_read_b64_tr_b16 v[78:79], v245 offset:3072
    s_waitcnt vmcnt(7) lgkmcnt(4)
    v_mfma_f32_32x32x16_bf16 v[144:159], v[64:67], a[128:131], 0
    ds_read_b64_tr_b16 v[80:81], v244 offset:4096
    ds_read_b64_tr_b16 v[82:83], v244 offset:5120
    v_mfma_f32_32x32x16_bf16 v[160:175], v[68:71], a[128:131], 0
    ds_read_b64_tr_b16 v[84:85], v245 offset:4096
    ds_read_b64_tr_b16 v[86:87], v245 offset:5120
    s_add_u32 s88, s88, 4096
    buffer_load_dwordx4 a[160:163], v243, s[72:75], s88 offen offset:0 sc1
    s_waitcnt vmcnt(7) lgkmcnt(4)
    v_mfma_f32_32x32x16_bf16 v[144:159], v[72:75], a[132:135], v[144:159]
    ds_read_b64_tr_b16 v[88:89], v244 offset:6144
    ds_read_b64_tr_b16 v[90:91], v244 offset:7168
    v_mfma_f32_32x32x16_bf16 v[160:175], v[76:79], a[132:135], v[160:175]
    ds_read_b64_tr_b16 v[92:93], v245 offset:6144
    ds_read_b64_tr_b16 v[94:95], v245 offset:7168
    buffer_load_dwordx4 a[164:167], v243, s[72:75], s88 offen offset:1024 sc1
    s_waitcnt vmcnt(7) lgkmcnt(4)
    v_mfma_f32_32x32x16_bf16 v[144:159], v[80:83], a[136:139], v[144:159]
    ds_read_b64_tr_b16 v[64:65], v244 offset:8192
    ds_read_b64_tr_b16 v[66:67], v244 offset:9216
    v_mfma_f32_32x32x16_bf16 v[160:175], v[84:87], a[136:139], v[160:175]
    ds_read_b64_tr_b16 v[68:69], v245 offset:8192
    ds_read_b64_tr_b16 v[70:71], v245 offset:9216
    buffer_load_dwordx4 a[168:171], v243, s[72:75], s88 offen offset:2048 sc1
    s_waitcnt vmcnt(7) lgkmcnt(4)
    v_mfma_f32_32x32x16_bf16 v[144:159], v[88:91], a[140:143], v[144:159]
    ds_read_b64_tr_b16 v[72:73], v244 offset:10240
    ds_read_b64_tr_b16 v[74:75], v244 offset:11264
    v_mfma_f32_32x32x16_bf16 v[160:175], v[92:95], a[140:143], v[160:175]
    ds_read_b64_tr_b16 v[76:77], v245 offset:10240
    ds_read_b64_tr_b16 v[78:79], v245 offset:11264
    buffer_load_dwordx4 a[172:175], v243, s[72:75], s88 offen offset:3072 sc1
    s_waitcnt vmcnt(7) lgkmcnt(4)
    v_mfma_f32_32x32x16_bf16 v[144:159], v[64:67], a[144:147], v[144:159]
    ds_read_b64_tr_b16 v[80:81], v244 offset:12288
    ds_read_b64_tr_b16 v[82:83], v244 offset:13312
    v_mfma_f32_32x32x16_bf16 v[160:175], v[68:71], a[144:147], v[160:175]
    ds_read_b64_tr_b16 v[84:85], v245 offset:12288
    ds_read_b64_tr_b16 v[86:87], v245 offset:13312
    s_add_u32 s88, s88, 4096
    buffer_load_dwordx4 a[176:179], v243, s[72:75], s88 offen offset:0 sc1
    s_waitcnt vmcnt(7) lgkmcnt(4)
    v_mfma_f32_32x32x16_bf16 v[144:159], v[72:75], a[148:151], v[144:159]
    ds_read_b64_tr_b16 v[88:89], v244 offset:14336
    ds_read_b64_tr_b16 v[90:91], v244 offset:15360
    v_mfma_f32_32x32x16_bf16 v[160:175], v[76:79], a[148:151], v[160:175]
    ds_read_b64_tr_b16 v[92:93], v245 offset:14336
    ds_read_b64_tr_b16 v[94:95], v245 offset:15360
    buffer_load_dwordx4 a[180:183], v243, s[72:75], s88 offen offset:1024 sc1
    s_waitcnt vmcnt(7) lgkmcnt(4)
    v_mfma_f32_32x32x16_bf16 v[144:159], v[80:83], a[152:155], v[144:159]
    ds_read_b64_tr_b16 v[64:65], v244 offset:16384
    ds_read_b64_tr_b16 v[66:67], v244 offset:17408
    v_mfma_f32_32x32x16_bf16 v[160:175], v[84:87], a[152:155], v[160:175]
    ds_read_b64_tr_b16 v[68:69], v245 offset:16384
    ds_read_b64_tr_b16 v[70:71], v245 offset:17408
    buffer_load_dwordx4 a[184:187], v243, s[72:75], s88 offen offset:2048 sc1
    s_waitcnt vmcnt(7) lgkmcnt(4)
    v_mfma_f32_32x32x16_bf16 v[144:159], v[88:91], a[156:159], v[144:159]
    ds_read_b64_tr_b16 v[72:73], v244 offset:18432
    ds_read_b64_tr_b16 v[74:75], v244 offset:19456
    v_mfma_f32_32x32x16_bf16 v[160:175], v[92:95], a[156:159], v[160:175]
    ds_read_b64_tr_b16 v[76:77], v245 offset:18432
    ds_read_b64_tr_b16 v[78:79], v245 offset:19456
    buffer_load_dwordx4 a[188:191], v243, s[72:75], s88 offen offset:3072 sc1
    s_waitcnt vmcnt(7) lgkmcnt(4)
    v_mfma_f32_32x32x16_bf16 v[144:159], v[64:67], a[160:163], v[144:159]
    ds_read_b64_tr_b16 v[80:81], v244 offset:20480
    ds_read_b64_tr_b16 v[82:83], v244 offset:21504
    v_mfma_f32_32x32x16_bf16 v[160:175], v[68:71], a[160:163], v[160:175]
    ds_read_b64_tr_b16 v[84:85], v245 offset:20480
    ds_read_b64_tr_b16 v[86:87], v245 offset:21504
    s_add_u32 m0, s12, 67584
    s_add_u32 s39, s15, 0
    s_and_b32 s39, s39, 63
    s_mul_i32 s39, s39, 24576
    s_lshl_b32 s83, s7, 7
    s_add_u32 s83, s83, s39
    buffer_load_dwordx4 v6, s[44:47], s83 offen lds
    s_waitcnt vmcnt(7) lgkmcnt(4)
    v_mfma_f32_32x32x16_bf16 v[144:159], v[72:75], a[164:167], v[144:159]
    ds_read_b64_tr_b16 v[88:89], v244 offset:22528
    ds_read_b64_tr_b16 v[90:91], v244 offset:23552
    v_mfma_f32_32x32x16_bf16 v[160:175], v[76:79], a[164:167], v[160:175]
    ds_read_b64_tr_b16 v[92:93], v245 offset:22528
    ds_read_b64_tr_b16 v[94:95], v245 offset:23552
    buffer_load_dwordx4 v141, s[44:47], s83 offen offset:1024 lds
    s_waitcnt vmcnt(7) lgkmcnt(4)
    v_mfma_f32_32x32x16_bf16 v[144:159], v[80:83], a[168:171], v[144:159]
    ds_read_b64_tr_b16 v[64:65], v244 offset:24576
    ds_read_b64_tr_b16 v[66:67], v244 offset:25600
    v_mfma_f32_32x32x16_bf16 v[160:175], v[84:87], a[168:171], v[160:175]
    ds_read_b64_tr_b16 v[68:69], v245 offset:24576
    ds_read_b64_tr_b16 v[70:71], v245 offset:25600
    buffer_load_dwordx4 v142, s[44:47], s83 offen offset:2048 lds
    s_waitcnt vmcnt(7) lgkmcnt(4)
    v_mfma_f32_32x32x16_bf16 v[144:159], v[88:91], a[172:175], v[144:159]
    ds_read_b64_tr_b16 v[72:73], v244 offset:26624
    ds_read_b64_tr_b16 v[74:75], v244 offset:27648
    v_mfma_f32_32x32x16_bf16 v[160:175], v[92:95], a[172:175], v[160:175]
    ds_read_b64_tr_b16 v[76:77], v245 offset:26624
    ds_read_b64_tr_b16 v[78:79], v245 offset:27648
    buffer_load_dwordx4 v143, s[44:47], s83 offen offset:3072 lds
    s_waitcnt vmcnt(7) lgkmcnt(4)
    v_mfma_f32_32x32x16_bf16 v[144:159], v[64:67], a[176:179], v[144:159]
    ds_read_b64_tr_b16 v[80:81], v244 offset:28672
    ds_read_b64_tr_b16 v[82:83], v244 offset:29696
    v_mfma_f32_32x32x16_bf16 v[160:175], v[68:71], a[176:179], v[160:175]
    ds_read_b64_tr_b16 v[84:85], v245 offset:28672
    ds_read_b64_tr_b16 v[86:87], v245 offset:29696
    s_add_u32 m0, s12, 83968
    s_add_u32 s39, s15, 16
    s_and_b32 s39, s39, 63
    s_mul_i32 s39, s39, 24576
    s_lshl_b32 s83, s7, 7
    s_add_u32 s83, s83, s39
    buffer_load_dwordx4 v6, s[44:47], s83 offen lds
    s_waitcnt vmcnt(7) lgkmcnt(4)
    v_mfma_f32_32x32x16_bf16 v[144:159], v[72:75], a[180:183], v[144:159]
    ds_read_b64_tr_b16 v[88:89], v244 offset:30720
    ds_read_b64_tr_b16 v[90:91], v244 offset:31744
    v_mfma_f32_32x32x16_bf16 v[160:175], v[76:79], a[180:183], v[160:175]
    ds_read_b64_tr_b16 v[92:93], v245 offset:30720
    ds_read_b64_tr_b16 v[94:95], v245 offset:31744
    buffer_load_dwordx4 v141, s[44:47], s83 offen offset:1024 lds
    s_waitcnt vmcnt(7) lgkmcnt(4)
    v_mfma_f32_32x32x16_bf16 v[144:159], v[80:83], a[184:187], v[144:159]
    v_mfma_f32_32x32x16_bf16 v[160:175], v[84:87], a[184:187], v[160:175]
    buffer_load_dwordx4 v142, s[44:47], s83 offen offset:2048 lds
    s_waitcnt vmcnt(7) lgkmcnt(0)
    v_mfma_f32_32x32x16_bf16 v[144:159], v[88:91], a[188:191], v[144:159]
    v_mfma_f32_32x32x16_bf16 v[160:175], v[92:95], a[188:191], v[160:175]
    buffer_load_dwordx4 v143, s[44:47], s83 offen offset:3072 lds
    s_barrier
    s_lshl_b32 s85, s3, 12
    s_add_u32 s86, s85, 51200
    v_add_u32 v192, s86, v4
    s_xor_b32 s85, s85, 8192
    s_add_u32 s85, s85, 51200
    v_add_u32 v193, s85, v4
    s_nop 5
    ds_write_b128 v192, v[160:163] offset:0
    ds_write_b128 v192, v[164:167] offset:1024
    ds_write_b128 v192, v[168:171] offset:2048
    ds_write_b128 v192, v[172:175] offset:3072
    s_waitcnt vmcnt(16)
    s_waitcnt lgkmcnt(0)
    s_barrier
    ds_read_b128 v[196:199], v193 offset:0
    ds_read_b128 v[200:203], v193 offset:1024
    ds_read_b128 v[204:207], v193 offset:2048
    ds_read_b128 v[208:211], v193 offset:3072
    s_cmp_lg_u32 s3, 3
    s_cbranch_scc1 L_askip_42
    s_mov_b64 s[94:95], exec
    s_mov_b64 exec, 1
    s_and_b32 s97, s6, 3
    s_lshl_b32 s97, s97, 8
    s_add_u32 s97, s97, s19
    s_add_u32 s97, s97, 1704960
    v_mov_b32 v248, s97
    v_mov_b32 v249, 1
    buffer_atomic_add v249, v248, s[72:75], 0 offen
    s_mov_b64 exec, s[94:95]
L_askip_42:
    s_waitcnt lgkmcnt(3)
    v_add_f32 v144, v144, v196
    v_add_f32 v145, v145, v197
    v_add_f32 v146, v146, v198
    v_add_f32 v147, v147, v199
    s_waitcnt lgkmcnt(2)
    v_add_f32 v148, v148, v200
    v_add_f32 v149, v149, v201
    v_add_f32 v150, v150, v202
    v_add_f32 v151, v151, v203
    s_waitcnt lgkmcnt(1)
    v_add_f32 v152, v152, v204
    v_add_f32 v153, v153, v205
    v_add_f32 v154, v154, v206
    v_add_f32 v155, v155, v207
    s_waitcnt lgkmcnt(0)
    v_add_f32 v156, v156, v208
    v_add_f32 v157, v157, v209
    v_add_f32 v158, v158, v210
    v_add_f32 v159, v159, v211
    v_lshlrev_b32 v212, 16, v16
    v_and_b32 v213, 0xffff0000, v16
    v_lshlrev_b32 v214, 16, v17
    v_and_b32 v215, 0xffff0000, v17
    v_lshlrev_b32 v216, 16, v18
    v_and_b32 v217, 0xffff0000, v18
    v_lshlrev_b32 v218, 16, v19
    v_and_b32 v219, 0xffff0000, v19
    v_lshlrev_b32 v220, 16, v20
    v_and_b32 v221, 0xffff0000, v20
    v_lshlrev_b32 v222, 16, v21
    v_and_b32 v223, 0xffff0000, v21
    v_lshlrev_b32 v224, 16, v22
    s_add_u32 m0, s12, 100352
    s_add_u32 s39, s15, 32
    s_and_b32 s39, s39, 63
    s_mul_i32 s39, s39, 24576
    s_lshl_b32 s83, s7, 7
    s_add_u32 s83, s83, s39
    buffer_load_dwordx4 v6, s[44:47], s83 offen lds
    v_and_b32 v225, 0xffff0000, v22
    v_lshlrev_b32 v226, 16, v23
    v_and_b32 v227, 0xffff0000, v23
    v_mov_b32 v228, v14
    v_mov_b32 v229, v14
    v_mov_b32 v230, v15
    v_mov_b32 v231, v15
    v_pk_add_f32 v[234:235], v[212:213], v[228:229]
    v_pk_fma_f32 v[144:145], v[234:235], v[230:231], v[144:145]
    v_pk_add_f32 v[24:25], v[212:213], v[144:145]
    v_mov_b32 v236, v144
    v_mov_b32 v237, v145
    v_pk_mul_f32 v[238:239], v[144:145], v[144:145]
    v_pk_add_f32 v[234:235], v[214:215], v[228:229]
    v_pk_fma_f32 v[146:147], v[234:235], v[230:231], v[146:147]
    v_pk_add_f32 v[26:27], v[214:215], v[146:147]
    buffer_load_dwordx4 v141, s[44:47], s83 offen offset:1024 lds
    v_pk_add_f32 v[236:237], v[236:237], v[146:147]
    v_pk_fma_f32 v[238:239], v[146:147], v[146:147], v[238:239]
    v_pk_add_f32 v[234:235], v[216:217], v[228:229]
    v_pk_fma_f32 v[148:149], v[234:235], v[230:231], v[148:149]
    v_pk_add_f32 v[28:29], v[216:217], v[148:149]
    v_pk_add_f32 v[236:237], v[236:237], v[148:149]
    v_pk_fma_f32 v[238:239], v[148:149], v[148:149], v[238:239]
    v_pk_add_f32 v[234:235], v[218:219], v[228:229]
    v_pk_fma_f32 v[150:151], v[234:235], v[230:231], v[150:151]
    v_pk_add_f32 v[30:31], v[218:219], v[150:151]
    v_pk_add_f32 v[236:237], v[236:237], v[150:151]
    v_pk_fma_f32 v[238:239], v[150:151], v[150:151], v[238:239]
    v_pk_add_f32 v[234:235], v[220:221], v[228:229]
    v_pk_fma_f32 v[152:153], v[234:235], v[230:231], v[152:153]
    v_pk_add_f32 v[32:33], v[220:221], v[152:153]
    v_pk_add_f32 v[236:237], v[236:237], v[152:153]
    buffer_load_dwordx4 v142, s[44:47], s83 offen offset:2048 lds
    v_pk_fma_f32 v[238:239], v[152:153], v[152:153], v[238:239]
    v_pk_add_f32 v[234:235], v[222:223], v[228:229]
    v_pk_fma_f32 v[154:155], v[234:235], v[230:231], v[154:155]
    v_pk_add_f32 v[34:35], v[222:223], v[154:155]
    v_pk_add_f32 v[236:237], v[236:237], v[154:155]
    v_pk_fma_f32 v[238:239], v[154:155], v[154:155], v[238:239]
    v_pk_add_f32 v[234:235], v[224:225], v[228:229]
    v_pk_fma_f32 v[156:157], v[234:235], v[230:231], v[156:157]
    v_pk_add_f32 v[36:37], v[224:225], v[156:157]
    v_pk_add_f32 v[236:237], v[236:237], v[156:157]
    v_pk_fma_f32 v[238:239], v[156:157], v[156:157], v[238:239]
    v_pk_add_f32 v[234:235], v[226:227], v[228:229]
    v_pk_fma_f32 v[158:159], v[234:235], v[230:231], v[158:159]
    v_pk_add_f32 v[38:39], v[226:227], v[158:159]
    v_pk_add_f32 v[236:237], v[236:237], v[158:159]
    v_pk_fma_f32 v[238:239], v[158:159], v[158:159], v[238:239]
    buffer_load_dwordx4 v143, s[44:47], s83 offen offset:3072 lds
    v_add_f32 v232, v236, v237
    v_add_f32 v233, v238, v239
    v_cvt_pk_bf16_f32 v212, v144, v145
    v_cvt_pk_bf16_f32 v213, v146, v147
    v_cvt_pk_bf16_f32 v214, v148, v149
    v_cvt_pk_bf16_f32 v215, v150, v151
    v_cvt_pk_bf16_f32 v216, v152, v153
    v_cvt_pk_bf16_f32 v217, v154, v155
    v_cvt_pk_bf16_f32 v218, v156, v157
    v_cvt_pk_bf16_f32 v219, v158, v159
    s_lshl_b32 s87, s20, 15
    s_lshl_b32 s86, s7, 12
    s_add_u32 s87, s87, s86
    s_lshl_b32 s86, s5, 11
    s_add_u32 s87, s87, s86
    s_add_u32 s87, s87, s19
    s_add_u32 s87, s87, 524288
    buffer_store_dwordx4 v[212:215], v4, s[72:75], s87 offen sc1
    buffer_store_dwordx4 v[216:219], v4, s[72:75], s87 offen offset:1024 sc1
    v_mov_b32 v234, v232
    s_add_u32 m0, s12, 116736
    s_add_u32 s39, s15, 48
    s_and_b32 s39, s39, 63
    s_mul_i32 s39, s39, 24576
    s_lshl_b32 s83, s7, 7
    s_add_u32 s83, s83, s39
    buffer_load_dwordx4 v6, s[44:47], s83 offen lds
    v_mov_b32 v235, v233
    s_nop 0
    v_permlane32_swap_b32 v232, v234
    v_permlane32_swap_b32 v233, v235
    v_add_f32 v232, v232, v234
    v_add_f32 v233, v233, v235
    s_lshl_b32 s85, s20, 12
    s_lshl_b32 s86, s7, 9
    s_add_u32 s85, s85, s86
    s_lshl_b32 s86, s5, 8
    s_add_u32 s85, s85, s86
    s_add_u32 s85, s85, s19
    s_add_u32 s85, s85, 1507328
    v_lshlrev_b32 v234, 3, v2
    buffer_store_dwordx2 v[232:233], v234, s[72:75], s85 offen sc1
    buffer_load_dwordx4 v141, s[44:47], s83 offen offset:1024 lds
    buffer_load_dwordx4 v142, s[44:47], s83 offen offset:2048 lds
    buffer_load_dwordx4 v143, s[44:47], s83 offen offset:3072 lds
    v_add_u32 v232, 65536, v10
    v_add_u32 v233, 131072, v10
    v_mov_b32 v206, 0
    v_mov_b32 v207, 0
    s_waitcnt vmcnt(15)
    s_barrier
    s_lshr_b32 s97, s2, 3
    s_lshl_b32 s97, s97, 2
    s_add_u32 s97, s97, s3
    s_mul_i32 s97, s97, 11264
    s_add_u32 s97, s97, 384
    s_cmp_ge_u32 s7, 4
    s_cselect_b32 s97, 0x7f000000, s97
    v_lshlrev_b32 v240, 10, v1
    s_mov_b64 s[94:95], exec
    s_bfm_b64 exec, 11, 0
    buffer_load_dword v255, v240, s[64:67], s97 offen
    s_mov_b64 exec, s[94:95]
    ds_read_b64_tr_b16 v[64:65], v232 offset:2048
    ds_read_b64_tr_b16 v[66:67], v232 offset:2560
    ds_read_b64_tr_b16 v[68:69], v232 offset:4096
    ds_read_b64_tr_b16 v[70:71], v232 offset:4608
    ds_read_b64_tr_b16 v[72:73], v232 offset:6144
    ds_read_b64_tr_b16 v[74:75], v232 offset:6656
    s_waitcnt lgkmcnt(4)
    v_mfma_f32_32x32x16_bf16 v[144:159], v[64:67], a[0:3], 0
    ds_read_b64_tr_b16 v[76:77], v232 offset:8192
    ds_read_b64_tr_b16 v[78:79], v232 offset:8704
    s_waitcnt lgkmcnt(4)
    v_mfma_f32_32x32x16_bf16 v[144:159], v[68:71], a[4:7], v[144:159]
    ds_read_b64_tr_b16 v[80:81], v232 offset:10240
    ds_read_b64_tr_b16 v[82:83], v232 offset:10752
    s_waitcnt lgkmcnt(4)
    v_mfma_f32_32x32x16_bf16 v[144:159], v[72:75], a[8:11], v[144:159]
    s_add_u32 m0, s32, 0
    s_add_u32 s39, s3, 8
    s_mul_i32 s39, s39, 44032
    s_lshl_b32 s92, s89, 6
    s_add_u32 s83, s39, s92
    buffer_load_dwordx4 v7, s[60:63], s83 offen lds
    ds_read_b64_tr_b16 v[84:85], v232 offset:12288
    ds_read_b64_tr_b16 v[86:87], v232 offset:12800
    s_waitcnt lgkmcnt(4)
    v_mfma_f32_32x32x16_bf16 v[144:159], v[76:79], a[12:15], v[144:159]
    ds_read_b64_tr_b16 v[88:89], v232 offset:14336
    ds_read_b64_tr_b16 v[90:91], v232 offset:14848
    s_waitcnt lgkmcnt(4)
    v_mfma_f32_32x32x16_bf16 v[144:159], v[80:83], a[16:19], v[144:159]
    ds_read_b64_tr_b16 v[92:93], v232 offset:16384
    ds_read_b64_tr_b16 v[94:95], v232 offset:16896
    s_waitcnt lgkmcnt(4)
    v_mfma_f32_32x32x16_bf16 v[144:159], v[84:87], a[20:23], v[144:159]
    buffer_load_dwordx4 v8, s[60:63], s83 offen offset:1024 lds
    s_waitcnt vmcnt(14)
    s_barrier
    ds_read_b64_tr_b16 v[96:97], v232 offset:18432
    ds_read_b64_tr_b16 v[98:99], v232 offset:18944
    s_waitcnt lgkmcnt(4)
    v_mfma_f32_32x32x16_bf16 v[144:159], v[88:91], a[24:27], v[144:159]
    ds_read_b64_tr_b16 v[100:101], v232 offset:20480
    ds_read_b64_tr_b16 v[102:103], v232 offset:20992
    s_waitcnt lgkmcnt(4)
    v_mfma_f32_32x32x16_bf16 v[144:159], v[92:95], a[28:31], v[144:159]
    ds_read_b64_tr_b16 v[104:105], v232 offset:22528
    ds_read_b64_tr_b16 v[106:107], v232 offset:23040
    s_waitcnt lgkmcnt(4)
    v_mfma_f32_32x32x16_bf16 v[144:159], v[96:99], a[32:35], v[144:159]
    buffer_load_dwordx4 v9, s[60:63], s83 offen offset:2048 lds
    ds_read_b64_tr_b16 v[108:109], v232 offset:24576
    ds_read_b64_tr_b16 v[110:111], v232 offset:25088
    s_waitcnt lgkmcnt(4)
    v_mfma_f32_32x32x16_bf16 v[144:159], v[100:103], a[36:39], v[144:159]
    ds_read_b64_tr_b16 v[112:113], v232 offset:26624
    ds_read_b64_tr_b16 v[114:115], v232 offset:27136
    s_waitcnt lgkmcnt(4)
    v_mfma_f32_32x32x16_bf16 v[144:159], v[104:107], a[40:43], v[144:159]
    s_cmp_lg_u32 s3, 3
    s_cbranch_scc1 L_piskip_43
    s_add_u32 s97, s6, -1
    s_max_i32 s97, s97, 0
    v_mov_b32 v250, s97
    v_lshrrev_b32 v251, 2, v250
    v_lshlrev_b32 v251, 21, v251
    v_and_b32 v250, 3, v250
    v_lshl_add_u32 v250, v250, 8, v251
    v_add_u32 v250, 1704960, v250
    v_mov_b32 v251, 8
    s_mov_b64 s[94:95], exec
    s_mov_b64 exec, 1
    buffer_load_dword v252, v250, s[72:75], 0 offen sc1
    s_mov_b64 exec, s[94:95]
L_piskip_43:
    ds_read_b64_tr_b16 v[116:117], v232 offset:28672
    ds_read_b64_tr_b16 v[118:119], v232 offset:29184
    s_waitcnt lgkmcnt(4)
    v_mfma_f32_32x32x16_bf16 v[144:159], v[108:111], a[44:47], v[144:159]
    s_add_u32 m0, m0, 12288
    s_add_u32 s83, s83, 176128
    buffer_load_dwordx4 v7, s[60:63], s83 offen lds
    ds_read_b64_tr_b16 v[120:121], v232 offset:30720
    ds_read_b64_tr_b16 v[122:123], v232 offset:31232
    s_waitcnt lgkmcnt(4)
    v_mfma_f32_32x32x16_bf16 v[144:159], v[112:115], a[48:51], v[144:159]
    ds_read_b64_tr_b16 v[124:125], v232 offset:32768
    ds_read_b64_tr_b16 v[126:127], v232 offset:33280
    s_waitcnt lgkmcnt(4)
    v_mfma_f32_32x32x16_bf16 v[144:159], v[116:119], a[52:55], v[144:159]
    s_waitcnt vmcnt(12)
    s_barrier
    ds_read_b64_tr_b16 v[128:129], v232 offset:34816
    ds_read_b64_tr_b16 v[130:131], v232 offset:35328
    s_waitcnt lgkmcnt(4)
    v_mfma_f32_32x32x16_bf16 v[144:159], v[120:123], a[56:59], v[144:159]
    buffer_load_dwordx4 v8, s[60:63], s83 offen offset:1024 lds
    ds_read_b64_tr_b16 v[132:133], v232 offset:36864
    ds_read_b64_tr_b16 v[134:135], v232 offset:37376
    s_waitcnt lgkmcnt(4)
    v_mfma_f32_32x32x16_bf16 v[144:159], v[124:127], a[60:63], v[144:159]
    v_dot2c_f32_bf16 v206, s80, v64
    v_dot2c_f32_bf16 v207, s80, v65
    v_dot2c_f32_bf16 v206, s80, v66
    v_dot2c_f32_bf16 v207, s80, v67
    v_dot2c_f32_bf16 v206, s80, v68
    v_dot2c_f32_bf16 v207, s80, v69
    v_dot2c_f32_bf16 v206, s80, v70
    v_dot2c_f32_bf16 v207, s80, v71
    v_dot2c_f32_bf16 v206, s80, v72
    v_dot2c_f32_bf16 v207, s80, v73
    v_dot2c_f32_bf16 v206, s80, v74
    v_dot2c_f32_bf16 v207, s80, v75
    buffer_load_dwordx4 v9, s[60:63], s83 offen offset:2048 lds
    v_dot2c_f32_bf16 v206, s80, v76
    v_dot2c_f32_bf16 v207, s80, v77
    v_dot2c_f32_bf16 v206, s80, v78
    v_dot2c_f32_bf16 v207, s80, v79
    v_dot2c_f32_bf16 v206, s80, v80
    v_dot2c_f32_bf16 v207, s80, v81
    v_dot2c_f32_bf16 v206, s80, v82
    v_dot2c_f32_bf16 v207, s80, v83
    v_dot2c_f32_bf16 v206, s80, v84
    v_dot2c_f32_bf16 v207, s80, v85
    v_dot2c_f32_bf16 v206, s80, v86
    v_dot2c_f32_bf16 v207, s80, v87
    v_dot2c_f32_bf16 v206, s80, v88
    v_dot2c_f32_bf16 v207, s80, v89
    v_dot2c_f32_bf16 v206, s80, v90
    v_dot2c_f32_bf16 v207, s80, v91
    v_dot2c_f32_bf16 v206, s80, v92
    v_dot2c_f32_bf16 v207, s80, v93
    v_dot2c_f32_bf16 v206, s80, v94
    v_dot2c_f32_bf16 v207, s80, v95
    s_add_u32 m0, m0, 12288
    s_add_u32 s83, s83, 176128
    buffer_load_dwordx4 v7, s[60:63], s83 offen lds
    v_dot2c_f32_bf16 v206, s80, v96
    v_dot2c_f32_bf16 v207, s80, v97
    v_dot2c_f32_bf16 v206, s80, v98
    v_dot2c_f32_bf16 v207, s80, v99
    v_dot2c_f32_bf16 v206, s80, v100
    v_dot2c_f32_bf16 v207, s80, v101
    v_dot2c_f32_bf16 v206, s80, v102
    v_dot2c_f32_bf16 v207, s80, v103
    v_dot2c_f32_bf16 v206, s80, v104
    v_dot2c_f32_bf16 v207, s80, v105
    v_dot2c_f32_bf16 v206, s80, v106
    v_dot2c_f32_bf16 v207, s80, v107
    v_dot2c_f32_bf16 v206, s80, v108
    v_dot2c_f32_bf16 v207, s80, v109
    v_dot2c_f32_bf16 v206, s80, v110
    v_dot2c_f32_bf16 v207, s80, v111
    v_dot2c_f32_bf16 v206, s80, v112
    v_dot2c_f32_bf16 v207, s80, v113
    v_dot2c_f32_bf16 v206, s80, v114
    v_dot2c_f32_bf16 v207, s80, v115
    v_dot2c_f32_bf16 v206, s80, v116
    v_dot2c_f32_bf16 v207, s80, v117
    v_dot2c_f32_bf16 v206, s80, v118
    v_dot2c_f32_bf16 v207, s80, v119
    buffer_load_dwordx4 v8, s[60:63], s83 offen offset:1024 lds
    v_dot2c_f32_bf16 v206, s80, v120
    v_dot2c_f32_bf16 v207, s80, v121
    v_dot2c_f32_bf16 v206, s80, v122
    v_dot2c_f32_bf16 v207, s80, v123
    v_dot2c_f32_bf16 v206, s80, v124
    v_dot2c_f32_bf16 v207, s80, v125
    v_dot2c_f32_bf16 v206, s80, v126
    v_dot2c_f32_bf16 v207, s80, v127
    ds_read_b64_tr_b16 v[64:65], v232 offset:38912
    ds_read_b64_tr_b16 v[66:67], v232 offset:39424
    s_waitcnt lgkmcnt(4)
    v_mfma_f32_32x32x16_bf16 v[144:159], v[128:131], a[64:67], v[144:159]
    ds_read_b64_tr_b16 v[68:69], v232 offset:40960
    ds_read_b64_tr_b16 v[70:71], v232 offset:41472
    s_waitcnt lgkmcnt(4)
    v_mfma_f32_32x32x16_bf16 v[144:159], v[132:135], a[68:71], v[144:159]
    buffer_load_dwordx4 v9, s[60:63], s83 offen offset:2048 lds
    ds_read_b64_tr_b16 v[72:73], v232 offset:43008
    ds_read_b64_tr_b16 v[74:75], v232 offset:43520
    s_waitcnt lgkmcnt(4)
    v_mfma_f32_32x32x16_bf16 v[144:159], v[64:67], a[72:75], v[144:159]
    ds_read_b64_tr_b16 v[76:77], v232 offset:45056
    ds_read_b64_tr_b16 v[78:79], v232 offset:45568
    s_waitcnt lgkmcnt(4)
    v_mfma_f32_32x32x16_bf16 v[144:159], v[68:71], a[76:79], v[144:159]
    ds_read_b64_tr_b16 v[80:81], v232 offset:47104
    ds_read_b64_tr_b16 v[82:83], v232 offset:47616
    s_waitcnt lgkmcnt(4)
    v_mfma_f32_32x32x16_bf16 v[144:159], v[72:75], a[80:83], v[144:159]
    s_add_u32 s92, s3, 12
    s_min_u32 s92, s92, 14
    s_mul_i32 s39, s92, 3072
    s_add_u32 m0, s39, 0
    s_add_u32 s39, s92, 8
    s_mul_i32 s39, s39, 44032
    s_lshl_b32 s92, s89, 6
    s_add_u32 s83, s39, s92
    buffer_load_dwordx4 v7, s[60:63], s83 offen lds
    ds_read_b64_tr_b16 v[84:85], v232 offset:49152
    ds_read_b64_tr_b16 v[86:87], v232 offset:49664
    s_waitcnt lgkmcnt(4)
    v_mfma_f32_32x32x16_bf16 v[144:159], v[76:79], a[84:87], v[144:159]
    s_waitcnt vmcnt(11)
    s_barrier
    ds_read_b64_tr_b16 v[88:89], v232 offset:51200
    ds_read_b64_tr_b16 v[90:91], v232 offset:51712
    s_waitcnt lgkmcnt(4)
    v_mfma_f32_32x32x16_bf16 v[144:159], v[80:83], a[88:91], v[144:159]
    ds_read_b64_tr_b16 v[92:93], v232 offset:53248
    ds_read_b64_tr_b16 v[94:95], v232 offset:53760
    s_waitcnt lgkmcnt(4)
    v_mfma_f32_32x32x16_bf16 v[144:159], v[84:87], a[92:95], v[144:159]
    buffer_load_dwordx4 v8, s[60:63], s83 offen offset:1024 lds
    ds_read_b64_tr_b16 v[96:97], v232 offset:55296
    ds_read_b64_tr_b16 v[98:99], v232 offset:55808
    s_waitcnt lgkmcnt(4)
    v_mfma_f32_32x32x16_bf16 v[144:159], v[88:91], a[96:99], v[144:159]
    s_cmp_lg_u32 s3, 3
    s_cbranch_scc1 L_pskip_44
    s_mov_b64 s[94:95], exec
    s_mov_b64 exec, 1
    s_mov_b32 s91, 400000
    s_waitcnt vmcnt(8)
    s_branch L_pchk_47
L_ploop_45:
    buffer_load_dword v252, v250, s[72:75], 0 offen sc1
    s_waitcnt vmcnt(0)
L_pchk_47:
    v_cmp_ge_u32 vcc, v252, v251
    s_sub_u32 s91, s91, 1
    s_cbranch_scc1 L_pdone_46
    s_cmp_eq_u64 vcc, exec
    s_cbranch_scc0 L_ploop_45
L_pdone_46:
    s_mov_b64 exec, s[94:95]
L_pskip_44:
    s_barrier
    v_mov_b32 v236, 0
    v_mov_b32 v237, 0
    v_mov_b32 v238, 0
    v_mov_b32 v239, 0
    s_cmp_eq_u32 s6, 0
    s_cbranch_scc1 L_nohalo_48
    s_add_u32 s86, s6, -1
    s_and_b32 s85, s86, 3
    s_lshl_b32 s85, s85, 3
    s_add_u32 s85, s85, s7
    s_lshl_b32 s85, s85, 12
    s_lshr_b32 s86, s86, 2
    s_lshl_b32 s86, s86, 21
    s_add_u32 s85, s85, s86
    s_add_u32 s85, s85, 1572864
    v_lshlrev_b32 v240, 4, v0
    buffer_load_dwordx4 v[236:239], v240, s[72:75], s85 offen sc1
L_nohalo_48:
    ds_read_b64_tr_b16 v[100:101], v232 offset:57344
    ds_read_b64_tr_b16 v[102:103], v232 offset:57856
    s_waitcnt lgkmcnt(4)
    v_mfma_f32_32x32x16_bf16 v[144:159], v[92:95], a[100:103], v[144:159]
    ds_read_b64_tr_b16 v[104:105], v232 offset:59392
    ds_read_b64_tr_b16 v[106:107], v232 offset:59904
    s_waitcnt lgkmcnt(4)
    v_mfma_f32_32x32x16_bf16 v[144:159], v[96:99], a[104:107], v[144:159]
    buffer_load_dwordx4 v9, s[60:63], s83 offen offset:2048 lds
    ds_read_b64_tr_b16 v[108:109], v232 offset:61440
    ds_read_b64_tr_b16 v[110:111], v232 offset:61952
    s_waitcnt lgkmcnt(4)
    v_mfma_f32_32x32x16_bf16 v[144:159], v[100:103], a[108:111], v[144:159]
    ds_read_b64_tr_b16 v[112:113], v232 offset:63488
    ds_read_b64_tr_b16 v[114:115], v232 offset:64000
    s_waitcnt lgkmcnt(4)
    v_mfma_f32_32x32x16_bf16 v[144:159], v[104:107], a[112:115], v[144:159]
    ds_read_b64_tr_b16 v[116:117], v233 offset:0
    ds_read_b64_tr_b16 v[118:119], v233 offset:512
    s_waitcnt lgkmcnt(4)
    v_mfma_f32_32x32x16_bf16 v[144:159], v[108:111], a[116:119], v[144:159]
    s_waitcnt lgkmcnt(2)
    v_mfma_f32_32x32x16_bf16 v[144:159], v[112:115], a[120:123], v[144:159]
    s_waitcnt lgkmcnt(0)
    v_mfma_f32_32x32x16_bf16 v[144:159], v[116:119], a[124:127], v[144:159]
    v_dot2c_f32_bf16 v206, s80, v128
    v_dot2c_f32_bf16 v207, s80, v129
    v_dot2c_f32_bf16 v206, s80, v130
    v_dot2c_f32_bf16 v207, s80, v131
    v_dot2c_f32_bf16 v206, s80, v132
    v_dot2c_f32_bf16 v207, s80, v133
    v_dot2c_f32_bf16 v206, s80, v134
    v_dot2c_f32_bf16 v207, s80, v135
    v_dot2c_f32_bf16 v206, s80, v64
    v_dot2c_f32_bf16 v207, s80, v65
    v_dot2c_f32_bf16 v206, s80, v66
    v_dot2c_f32_bf16 v207, s80, v67
    v_dot2c_f32_bf16 v206, s80, v68
    v_dot2c_f32_bf16 v207, s80, v69
    v_dot2c_f32_bf16 v206, s80, v70
    v_dot2c_f32_bf16 v207, s80, v71
    v_dot2c_f32_bf16 v206, s80, v72
    v_dot2c_f32_bf16 v207, s80, v73
    v_dot2c_f32_bf16 v206, s80, v74
    v_dot2c_f32_bf16 v207, s80, v75
    v_dot2c_f32_bf16 v206, s80, v76
    v_dot2c_f32_bf16 v207, s80, v77
    v_dot2c_f32_bf16 v206, s80, v78
    v_dot2c_f32_bf16 v207, s80, v79
    v_dot2c_f32_bf16 v206, s80, v80
    v_dot2c_f32_bf16 v207, s80, v81
    v_dot2c_f32_bf16 v206, s80, v82
    v_dot2c_f32_bf16 v207, s80, v83
    v_dot2c_f32_bf16 v206, s80, v84
    v_dot2c_f32_bf16 v207, s80, v85
    v_dot2c_f32_bf16 v206, s80, v86
    v_dot2c_f32_bf16 v207, s80, v87
    v_dot2c_f32_bf16 v206, s80, v88
    v_dot2c_f32_bf16 v207, s80, v89
    v_dot2c_f32_bf16 v206, s80, v90
    v_dot2c_f32_bf16 v207, s80, v91
    v_dot2c_f32_bf16 v206, s80, v92
    v_dot2c_f32_bf16 v207, s80, v93
    v_dot2c_f32_bf16 v206, s80, v94
    v_dot2c_f32_bf16 v207, s80, v95
    v_dot2c_f32_bf16 v206, s80, v96
    v_dot2c_f32_bf16 v207, s80, v97
    v_dot2c_f32_bf16 v206, s80, v98
    v_dot2c_f32_bf16 v207, s80, v99
    v_dot2c_f32_bf16 v206, s80, v100
    v_dot2c_f32_bf16 v207, s80, v101
    v_dot2c_f32_bf16 v206, s80, v102
    v_dot2c_f32_bf16 v207, s80, v103
    v_dot2c_f32_bf16 v206, s80, v104
    v_dot2c_f32_bf16 v207, s80, v105
    v_dot2c_f32_bf16 v206, s80, v106
    v_dot2c_f32_bf16 v207, s80, v107
    v_dot2c_f32_bf16 v206, s80, v108
    v_dot2c_f32_bf16 v207, s80, v109
    v_dot2c_f32_bf16 v206, s80, v110
    v_dot2c_f32_bf16 v207, s80, v111
    v_dot2c_f32_bf16 v206, s80, v112
    v_dot2c_f32_bf16 v207, s80, v113
    v_dot2c_f32_bf16 v206, s80, v114
    v_dot2c_f32_bf16 v207, s80, v115
    v_dot2c_f32_bf16 v206, s80, v116
    v_dot2c_f32_bf16 v207, s80, v117
    v_dot2c_f32_bf16 v206, s80, v118
    v_dot2c_f32_bf16 v207, s80, v119
    s_waitcnt vmcnt(16)
    s_barrier
    s_cmp_lg_u32 s3, 3
    s_cbranch_scc1 L_askip_49
    s_mov_b64 s[94:95], exec
    s_mov_b64 exec, 1
    s_and_b32 s97, s8, 1
    s_lshl_b32 s97, s97, 8
    s_add_u32 s97, s97, s19
    s_add_u32 s97, s97, 1705984
    v_mov_b32 v248, s97
    v_mov_b32 v249, 1
    buffer_atomic_add v249, v248, s[72:75], 0 offen
    s_mov_b64 exec, s[94:95]
L_askip_49:
    v_cmp_gt_u32 vcc, 32, v1
    s_nop 1
    v_add_f32 v206, v206, v207
    v_mov_b32 v225, v206
    s_nop 1
    v_permlane32_swap_b32 v206, v225
    s_nop 0
    v_add_f32 v206, v206, v225
    v_cndmask_b32 v206, 0, v206, vcc
    s_nop 1
    v_mfma_f32_32x32x2_f32 v[144:159], v206, v14, v[144:159]
    s_add_u32 m0, s12, 67584
    s_add_u32 s83, s27, 0
    buffer_load_dwordx4 v5, s[48:51], s83 offen lds
    buffer_load_dwordx4 v136, s[48:51], s83 offen offset:1024 lds
    buffer_load_dwordx4 v137, s[48:51], s83 offen offset:2048 lds
    s_nop 12
    v_mul_f32 v144, v15, v144
    buffer_load_dwordx4 v138, s[48:51], s83 offen offset:3072 lds
    v_mul_f32 v145, v15, v145
    v_cvt_pk_bf16_f32 v56, v144, v145
    v_mul_f32 v146, v15, v146
    v_mul_f32 v147, v15, v147
    v_cvt_pk_bf16_f32 v57, v146, v147
    v_mul_f32 v148, v15, v148
    v_mul_f32 v149, v15, v149
    v_cvt_pk_bf16_f32 v58, v148, v149
    v_mul_f32 v150, v15, v150
    v_mul_f32 v151, v15, v151
    v_cvt_pk_bf16_f32 v59, v150, v151
    v_mul_f32 v152, v15, v152
    v_mul_f32 v153, v15, v153
    v_cvt_pk_bf16_f32 v60, v152, v153
    v_mul_f32 v154, v15, v154
    v_mul_f32 v155, v15, v155
    s_add_u32 m0, s12, 83968
    s_add_u32 s83, s27, 131072
    buffer_load_dwordx4 v5, s[48:51], s83 offen lds
    v_cvt_pk_bf16_f32 v61, v154, v155
    v_mul_f32 v156, v15, v156
    v_mul_f32 v157, v15, v157
    v_cvt_pk_bf16_f32 v62, v156, v157
    v_mul_f32 v158, v15, v158
    v_mul_f32 v159, v15, v159
    v_cvt_pk_bf16_f32 v63, v158, v159
    s_nop 1
    v_permlane32_swap_b32 v56, v60
    v_permlane32_swap_b32 v57, v61
    v_permlane32_swap_b32 v58, v62
    v_permlane32_swap_b32 v59, v63
    s_lshl_b32 s85, s5, 1
    v_add_u32 v193, s85, v3
    v_mul_u32_u24 v193, 2560, v193
    s_lshl_b32 s85, s4, 5
    s_add_u32 s85, s85, 16
    v_add_u32 v194, s85, v2
    v_lshl_add_u32 v192, v194, 4, v193
    v_add_u32 v192, 46080, v192
    ds_write_b128 v192, v[40:43]
    ds_write_b128 v192, v[44:47] offset:1280
    ds_write_b128 v192, v[48:51] offset:10240
    ds_write_b128 v192, v[52:55] offset:11520
    s_waitcnt vmcnt(6)
    v_lshrrev_b32 v200, 4, v0
    v_mul_u32_u24 v200, 1280, v200
    v_and_b32 v201, 15, v0
    v_lshl_add_u32 v200, v201, 4, v200
    v_add_u32 v200, 46080, v200
    ds_write_b128 v200, v[236:239]
    s_waitcnt lgkmcnt(0)
    s_barrier
    v_subrev_u32 v202, 224, v192
    ds_read_b128 v[64:67], v202 offset:224
    ds_read_b128 v[68:71], v202 offset:1504
    ds_read_b128 v[72:75], v202 offset:192
    buffer_load_dwordx4 v136, s[48:51], s83 offen offset:1024 lds
    ds_read_b128 v[76:79], v202 offset:1472
    ds_read_b128 v[80:83], v202 offset:160
    ds_read_b128 v[84:87], v202 offset:1440
    ds_read_b128 v[88:91], v202 offset:128
    ds_read_b128 v[92:95], v202 offset:1408
    ds_read_b128 v[96:99], v202 offset:96
    buffer_load_dwordx4 v137, s[48:51], s83 offen offset:2048 lds
    ds_read_b128 v[100:103], v202 offset:1376
    ds_read_b128 v[104:107], v202 offset:64
    ds_read_b128 v[108:111], v202 offset:1344
    ds_read_b128 v[112:115], v202 offset:32
    ds_read_b128 v[116:119], v202 offset:1312
    ds_read_b128 v[120:123], v202 offset:0
    buffer_load_dwordx4 v138, s[48:51], s83 offen offset:3072 lds
    ds_read_b128 v[124:127], v202 offset:1280
    v_mov_b32 v204, 0
    v_mov_b32 v205, 0
    v_mov_b32 v206, 0
    v_mov_b32 v207, 0
    v_mov_b32 v208, 0
    v_mov_b32 v209, 0
    v_mov_b32 v210, 0
    v_mov_b32 v211, 0
    s_waitcnt lgkmcnt(14)
    v_dot2c_f32_bf16 v204, v56, v64
    v_dot2c_f32_bf16 v204, v57, v65
    v_dot2c_f32_bf16 v204, v58, v66
    v_dot2c_f32_bf16 v204, v59, v67
    s_add_u32 m0, s12, 100352
    s_add_u32 s83, s27, 262144
    buffer_load_dwordx4 v5, s[48:51], s83 offen lds
    v_dot2c_f32_bf16 v204, v60, v68
    v_dot2c_f32_bf16 v204, v61, v69
    v_dot2c_f32_bf16 v204, v62, v70
    v_dot2c_f32_bf16 v204, v63, v71
    s_waitcnt lgkmcnt(12)
    v_dot2c_f32_bf16 v205, v56, v72
    v_dot2c_f32_bf16 v205, v57, v73
    v_dot2c_f32_bf16 v205, v58, v74
    v_dot2c_f32_bf16 v205, v59, v75
    v_dot2c_f32_bf16 v205, v60, v76
    v_dot2c_f32_bf16 v205, v61, v77
    v_dot2c_f32_bf16 v205, v62, v78
    v_dot2c_f32_bf16 v205, v63, v79
    s_waitcnt lgkmcnt(10)
    v_dot2c_f32_bf16 v206, v56, v80
    v_dot2c_f32_bf16 v206, v57, v81
    buffer_load_dwordx4 v136, s[48:51], s83 offen offset:1024 lds
    v_dot2c_f32_bf16 v206, v58, v82
    v_dot2c_f32_bf16 v206, v59, v83
    v_dot2c_f32_bf16 v206, v60, v84
    v_dot2c_f32_bf16 v206, v61, v85
    v_dot2c_f32_bf16 v206, v62, v86
    v_dot2c_f32_bf16 v206, v63, v87
    s_waitcnt lgkmcnt(8)
    v_dot2c_f32_bf16 v207, v56, v88
    v_dot2c_f32_bf16 v207, v57, v89
    v_dot2c_f32_bf16 v207, v58, v90
    v_dot2c_f32_bf16 v207, v59, v91
    v_dot2c_f32_bf16 v207, v60, v92
    v_dot2c_f32_bf16 v207, v61, v93
    v_dot2c_f32_bf16 v207, v62, v94
    v_dot2c_f32_bf16 v207, v63, v95
    s_waitcnt lgkmcnt(6)
    v_dot2c_f32_bf16 v208, v56, v96
    buffer_load_dwordx4 v137, s[48:51], s83 offen offset:2048 lds
    v_dot2c_f32_bf16 v208, v57, v97
    v_dot2c_f32_bf16 v208, v58, v98
    v_dot2c_f32_bf16 v208, v59, v99
    v_dot2c_f32_bf16 v208, v60, v100
    v_dot2c_f32_bf16 v208, v61, v101
    v_dot2c_f32_bf16 v208, v62, v102
    v_dot2c_f32_bf16 v208, v63, v103
    s_waitcnt lgkmcnt(4)
    v_dot2c_f32_bf16 v209, v56, v104
    v_dot2c_f32_bf16 v209, v57, v105
    v_dot2c_f32_bf16 v209, v58, v106
    v_dot2c_f32_bf16 v209, v59, v107
    v_dot2c_f32_bf16 v209, v60, v108
    v_dot2c_f32_bf16 v209, v61, v109
    v_dot2c_f32_bf16 v209, v62, v110
    v_dot2c_f32_bf16 v209, v63, v111
    buffer_load_dwordx4 v138, s[48:51], s83 offen offset:3072 lds
    s_waitcnt lgkmcnt(2)
    v_dot2c_f32_bf16 v210, v56, v112
    v_dot2c_f32_bf16 v210, v57, v113
    v_dot2c_f32_bf16 v210, v58, v114
    v_dot2c_f32_bf16 v210, v59, v115
    v_dot2c_f32_bf16 v210, v60, v116
    v_dot2c_f32_bf16 v210, v61, v117
    v_dot2c_f32_bf16 v210, v62, v118
    v_dot2c_f32_bf16 v210, v63, v119
    s_waitcnt lgkmcnt(0)
    v_dot2c_f32_bf16 v211, v56, v120
    v_dot2c_f32_bf16 v211, v57, v121
    v_dot2c_f32_bf16 v211, v58, v122
    v_dot2c_f32_bf16 v211, v59, v123
    v_dot2c_f32_bf16 v211, v60, v124
    v_dot2c_f32_bf16 v211, v61, v125
    s_add_u32 m0, s12, 116736
    s_add_u32 s83, s27, 393216
    buffer_load_dwordx4 v5, s[48:51], s83 offen lds
    v_dot2c_f32_bf16 v211, v62, v126
    v_dot2c_f32_bf16 v211, v63, v127
    s_cmp_lg_u32 s3, 3
    s_cbranch_scc1 L_piskip_50
    s_and_b32 s97, s8, 1
    s_lshl_b32 s97, s97, 8
    s_add_u32 s97, s97, s19
    s_add_u32 s97, s97, 1705984
    v_mov_b32 v250, s97
    v_mov_b32 v251, 16
    s_mov_b64 s[94:95], exec
    s_mov_b64 exec, 1
    buffer_load_dword v252, v250, s[72:75], 0 offen sc1
    s_mov_b64 exec, s[94:95]
L_piskip_50:
    s_nop 2
    ds_read_b128 v[64:67], v202 offset:10464
    ds_read_b128 v[68:71], v202 offset:11744
    ds_read_b128 v[72:75], v202 offset:10432
    ds_read_b128 v[76:79], v202 offset:11712
    buffer_load_dwordx4 v136, s[48:51], s83 offen offset:1024 lds
    ds_read_b128 v[80:83], v202 offset:10400
    ds_read_b128 v[84:87], v202 offset:11680
    ds_read_b128 v[88:91], v202 offset:10368
    ds_read_b128 v[92:95], v202 offset:11648
    ds_read_b128 v[96:99], v202 offset:10336
    ds_read_b128 v[100:103], v202 offset:11616
    buffer_load_dwordx4 v137, s[48:51], s83 offen offset:2048 lds
    ds_read_b128 v[104:107], v202 offset:10304
    ds_read_b128 v[108:111], v202 offset:11584
    ds_read_b128 v[112:115], v202 offset:10272
    ds_read_b128 v[116:119], v202 offset:11552
    ds_read_b128 v[120:123], v202 offset:10240
    ds_read_b128 v[124:127], v202 offset:11520
    buffer_load_dwordx4 v138, s[48:51], s83 offen offset:3072 lds
    s_cmp_lg_u32 s6, 0
    s_cbranch_scc1 L_nomask_51
    s_lshl_b32 s85, s4, 5
    v_add_u32 v203, s85, v2
    v_mov_b32 v212, 0xff800000
    v_cmp_le_u32 vcc, 2, v203
    s_nop 1
    v_cndmask_b32 v205, v212, v205, vcc
    v_cmp_le_u32 vcc, 4, v203
    s_nop 1
    v_cndmask_b32 v206, v212, v206, vcc
    v_cmp_le_u32 vcc, 6, v203
    s_nop 1
    v_cndmask_b32 v207, v212, v207, vcc
    v_cmp_le_u32 vcc, 8, v203
    s_nop 1
    v_cndmask_b32 v208, v212, v208, vcc
    v_cmp_le_u32 vcc, 10, v203
    s_nop 1
    v_cndmask_b32 v209, v212, v209, vcc
    v_cmp_le_u32 vcc, 12, v203
    s_nop 1
    v_cndmask_b32 v210, v212, v210, vcc
    v_cmp_le_u32 vcc, 14, v203
    s_nop 1
    v_cndmask_b32 v211, v212, v211, vcc
L_nomask_51:
    v_max3_f32 v212, v204, v205, v206
    v_max3_f32 v212, v212, v207, v208
    v_max3_f32 v212, v212, v209, v210
    v_max_f32 v212, v212, v211
    s_mov_b32 s85, 0x3eb8aa3b
    v_mul_f32 v212, 0xbeb8aa3b, v212
    v_fma_f32 v204, v204, s85, v212
    v_fma_f32 v205, v205, s85, v212
    v_fma_f32 v206, v206, s85, v212
    v_fma_f32 v207, v207, s85, v212
    v_fma_f32 v208, v208, s85, v212
    v_fma_f32 v209, v209, s85, v212
    v_fma_f32 v210, v210, s85, v212
    v_fma_f32 v211, v211, s85, v212
    v_exp_f32 v204, v204
    v_exp_f32 v205, v205
    v_exp_f32 v206, v206
    v_exp_f32 v207, v207
    v_exp_f32 v208, v208
    v_exp_f32 v209, v209
    v_exp_f32 v210, v210
    v_exp_f32 v211, v211
    v_add_f32 v213, v204, v205
    v_add_f32 v213, v213, v206
    v_add_f32 v213, v213, v207
    v_add_f32 v213, v213, v208
    v_add_f32 v213, v213, v209
    v_add_f32 v213, v213, v210
    v_add_f32 v213, v213, v211
    v_rcp_f32 v213, v213
    s_nop 0
    v_mul_f32 v204, v213, v204
    v_mul_f32 v205, v213, v205
    v_mul_f32 v206, v213, v206
    v_mul_f32 v207, v213, v207
    v_mul_f32 v208, v213, v208
    v_mul_f32 v209, v213, v209
    v_mul_f32 v210, v213, v210
    v_mul_f32 v211, v213, v211
    v_cvt_pk_bf16_f32 v214, v204, v205
    v_cvt_pk_bf16_f32 v215, v206, v207
    v_cvt_pk_bf16_f32 v216, v208, v209
    v_cvt_pk_bf16_f32 v217, v210, v211
    s_lshl_b32 s16, s21, 15
    s_add_u32 s16, s16, s19
    s_add_u32 s16, s16, 524288
    s_lshl_b32 s17, s21, 12
    s_add_u32 s17, s17, s19
    s_add_u32 s17, s17, 1507328
    s_mul_i32 s18, s21, 88064
    s_add_u32 s18, s18, s19
    s_add_u32 s18, s18, 786432
    s_lshl_b32 s86, s89, 11
    s_add_u32 s18, s18, s86
    s_cmp_lg_u32 s3, 3
    s_cbranch_scc1 L_pskip_52
    s_mov_b64 s[94:95], exec
    s_mov_b64 exec, 1
    s_mov_b32 s91, 400000
    s_waitcnt vmcnt(3)
    s_branch L_pchk_55
L_ploop_53:
    buffer_load_dword v252, v250, s[72:75], 0 offen sc1
    s_waitcnt vmcnt(0)
L_pchk_55:
    v_cmp_ge_u32 vcc, v252, v251
    s_sub_u32 s91, s91, 1
    s_cbranch_scc1 L_pdone_54
    s_cmp_eq_u64 vcc, exec
    s_cbranch_scc0 L_ploop_53
L_pdone_54:
    s_mov_b64 exec, s[94:95]
L_pskip_52:
    s_barrier
    s_waitcnt lgkmcnt(12)
    v_perm_b32 v218, v72, v64, s81
    s_add_u32 s35, s30, 0
    s_and_b32 s35, s35, 7
    s_lshl_b32 s35, s35, 12
    s_add_u32 s35, s35, s16
    buffer_load_dwordx4 a[0:3], v4, s[72:75], s35 offen offset:0 sc1
    v_perm_b32 v219, v72, v64, s82
    v_dot2_f32_bf16 v144, v218, v214, 0
    v_dot2_f32_bf16 v145, v219, v214, 0
    v_perm_b32 v220, v73, v65, s81
    v_perm_b32 v221, v73, v65, s82
    v_dot2_f32_bf16 v146, v220, v214, 0
    v_dot2_f32_bf16 v147, v221, v214, 0
    v_perm_b32 v218, v74, v66, s81
    v_perm_b32 v219, v74, v66, s82
    v_dot2_f32_bf16 v148, v218, v214, 0
    v_dot2_f32_bf16 v149, v219, v214, 0
    v_perm_b32 v220, v75, v67, s81
    v_perm_b32 v221, v75, v67, s82
    v_dot2_f32_bf16 v150, v220, v214, 0
    v_dot2_f32_bf16 v151, v221, v214, 0
    v_perm_b32 v218, v76, v68, s81
    buffer_load_dwordx4 a[4:7], v4, s[72:75], s35 offen offset:1024 sc1
    v_perm_b32 v219, v76, v68, s82
    v_dot2_f32_bf16 v152, v218, v214, 0
    v_dot2_f32_bf16 v153, v219, v214, 0
    v_perm_b32 v220, v77, v69, s81
    v_perm_b32 v221, v77, v69, s82
    v_dot2_f32_bf16 v154, v220, v214, 0
    v_dot2_f32_bf16 v155, v221, v214, 0
    v_perm_b32 v218, v78, v70, s81
    v_perm_b32 v219, v78, v70, s82
    v_dot2_f32_bf16 v156, v218, v214, 0
    v_dot2_f32_bf16 v157, v219, v214, 0
    v_perm_b32 v220, v79, v71, s81
    v_perm_b32 v221, v79, v71, s82
    v_dot2_f32_bf16 v158, v220, v214, 0
    v_dot2_f32_bf16 v159, v221, v214, 0
    s_waitcnt lgkmcnt(8)
    v_perm_b32 v218, v88, v80, s81
    buffer_load_dwordx4 a[8:11], v4, s[72:75], s35 offen offset:2048 sc1
    v_perm_b32 v219, v88, v80, s82
    v_dot2c_f32_bf16 v144, v218, v215
    v_dot2c_f32_bf16 v145, v219, v215
    v_perm_b32 v220, v89, v81, s81
    v_perm_b32 v221, v89, v81, s82
    v_dot2c_f32_bf16 v146, v220, v215
    v_dot2c_f32_bf16 v147, v221, v215
    v_perm_b32 v218, v90, v82, s81
    v_perm_b32 v219, v90, v82, s82
    v_dot2c_f32_bf16 v148, v218, v215
    v_dot2c_f32_bf16 v149, v219, v215
    v_perm_b32 v220, v91, v83, s81
    v_perm_b32 v221, v91, v83, s82
    v_dot2c_f32_bf16 v150, v220, v215
    v_dot2c_f32_bf16 v151, v221, v215
    v_perm_b32 v218, v92, v84, s81
    buffer_load_dwordx4 a[12:15], v4, s[72:75], s35 offen offset:3072 sc1
    v_perm_b32 v219, v92, v84, s82
    v_dot2c_f32_bf16 v152, v218, v215
    v_dot2c_f32_bf16 v153, v219, v215
    v_perm_b32 v220, v93, v85, s81
    v_perm_b32 v221, v93, v85, s82
    v_dot2c_f32_bf16 v154, v220, v215
    v_dot2c_f32_bf16 v155, v221, v215
    v_perm_b32 v218, v94, v86, s81
    v_perm_b32 v219, v94, v86, s82
    v_dot2c_f32_bf16 v156, v218, v215
    v_dot2c_f32_bf16 v157, v219, v215
    v_perm_b32 v220, v95, v87, s81
    v_perm_b32 v221, v95, v87, s82
    v_dot2c_f32_bf16 v158, v220, v215
    v_dot2c_f32_bf16 v159, v221, v215
    s_waitcnt lgkmcnt(4)
    v_perm_b32 v218, v104, v96, s81
    s_add_u32 s35, s30, 1
    s_and_b32 s35, s35, 7
    s_lshl_b32 s35, s35, 12
    s_add_u32 s35, s35, s16
    buffer_load_dwordx4 a[16:19], v4, s[72:75], s35 offen offset:0 sc1
    v_perm_b32 v219, v104, v96, s82
    v_dot2c_f32_bf16 v144, v218, v216
    v_dot2c_f32_bf16 v145, v219, v216
    v_perm_b32 v220, v105, v97, s81
    v_perm_b32 v221, v105, v97, s82
    v_dot2c_f32_bf16 v146, v220, v216
    v_dot2c_f32_bf16 v147, v221, v216
    v_perm_b32 v218, v106, v98, s81
    v_perm_b32 v219, v106, v98, s82
    v_dot2c_f32_bf16 v148, v218, v216
    v_dot2c_f32_bf16 v149, v219, v216
    v_perm_b32 v220, v107, v99, s81
    v_perm_b32 v221, v107, v99, s82
    v_dot2c_f32_bf16 v150, v220, v216
    v_dot2c_f32_bf16 v151, v221, v216
    v_perm_b32 v218, v108, v100, s81
    buffer_load_dwordx4 a[20:23], v4, s[72:75], s35 offen offset:1024 sc1
    v_perm_b32 v219, v108, v100, s82
    v_dot2c_f32_bf16 v152, v218, v216
    v_dot2c_f32_bf16 v153, v219, v216
    v_perm_b32 v220, v109, v101, s81
    v_perm_b32 v221, v109, v101, s82
    v_dot2c_f32_bf16 v154, v220, v216
    v_dot2c_f32_bf16 v155, v221, v216
    v_perm_b32 v218, v110, v102, s81
    v_perm_b32 v219, v110, v102, s82
    v_dot2c_f32_bf16 v156, v218, v216
    v_dot2c_f32_bf16 v157, v219, v216
    v_perm_b32 v220, v111, v103, s81
    v_perm_b32 v221, v111, v103, s82
    v_dot2c_f32_bf16 v158, v220, v216
    v_dot2c_f32_bf16 v159, v221, v216
    s_waitcnt lgkmcnt(0)
    v_perm_b32 v218, v120, v112, s81
    buffer_load_dwordx4 a[24:27], v4, s[72:75], s35 offen offset:2048 sc1
    v_perm_b32 v219, v120, v112, s82
    v_dot2c_f32_bf16 v144, v218, v217
    v_dot2c_f32_bf16 v145, v219, v217
    v_perm_b32 v220, v121, v113, s81
    v_perm_b32 v221, v121, v113, s82
    v_dot2c_f32_bf16 v146, v220, v217
    v_dot2c_f32_bf16 v147, v221, v217
    v_perm_b32 v218, v122, v114, s81
    v_perm_b32 v219, v122, v114, s82
    v_dot2c_f32_bf16 v148, v218, v217
    v_dot2c_f32_bf16 v149, v219, v217
    v_perm_b32 v220, v123, v115, s81
    v_perm_b32 v221, v123, v115, s82
    v_dot2c_f32_bf16 v150, v220, v217
    v_dot2c_f32_bf16 v151, v221, v217
    v_perm_b32 v218, v124, v116, s81
    buffer_load_dwordx4 a[28:31], v4, s[72:75], s35 offen offset:3072 sc1
    v_perm_b32 v219, v124, v116, s82
    v_dot2c_f32_bf16 v152, v218, v217
    v_dot2c_f32_bf16 v153, v219, v217
    v_perm_b32 v220, v125, v117, s81
    v_perm_b32 v221, v125, v117, s82
    v_dot2c_f32_bf16 v154, v220, v217
    v_dot2c_f32_bf16 v155, v221, v217
    v_perm_b32 v218, v126, v118, s81
    v_perm_b32 v219, v126, v118, s82
    v_dot2c_f32_bf16 v156, v218, v217
    v_dot2c_f32_bf16 v157, v219, v217
    v_perm_b32 v220, v127, v119, s81
    v_perm_b32 v221, v127, v119, s82
    v_dot2c_f32_bf16 v158, v220, v217
    v_dot2c_f32_bf16 v159, v221, v217
    s_nop 2
    v_cvt_pk_bf16_f32 v224, v144, v145
    s_add_u32 s35, s30, 2
    s_and_b32 s35, s35, 7
    s_lshl_b32 s35, s35, 12
    s_add_u32 s35, s35, s16
    buffer_load_dwordx4 a[32:35], v4, s[72:75], s35 offen offset:0 sc1
    v_cvt_pk_bf16_f32 v225, v146, v147
    v_cvt_pk_bf16_f32 v226, v148, v149
    v_cvt_pk_bf16_f32 v227, v150, v151
    v_cvt_pk_bf16_f32 v228, v152, v153
    v_cvt_pk_bf16_f32 v229, v154, v155
    v_cvt_pk_bf16_f32 v230, v156, v157
    v_cvt_pk_bf16_f32 v231, v158, v159
    s_nop 1
    v_permlane32_swap_b32 v224, v228
    v_permlane32_swap_b32 v225, v229
    v_permlane32_swap_b32 v226, v230
    v_permlane32_swap_b32 v227, v231
    s_lshl_b32 s85, s20, 15
    s_lshl_b32 s86, s7, 12
    s_add_u32 s85, s85, s86
    s_lshl_b32 s86, s5, 11
    s_add_u32 s85, s85, s86
    s_add_u32 s85, s85, s19
    s_add_u32 s85, s85, 262144
    buffer_store_dwordx4 v[224:227], v4, s[72:75], s85 offen sc1
    buffer_store_dwordx4 v[228:231], v4, s[72:75], s85 offen offset:1024 sc1
    s_waitcnt vmcnt(11)
    s_barrier
    s_add_u32 m0, s32, 46080
    s_add_u32 s39, s3, 23
    s_mul_i32 s39, s39, 44032
    s_lshl_b32 s92, s89, 6
    s_add_u32 s83, s39, s92
    buffer_load_dwordx4 v7, s[60:63], s83 offen lds
    buffer_load_dwordx4 v8, s[60:63], s83 offen offset:1024 lds
    buffer_load_dwordx4 v9, s[60:63], s83 offen offset:2048 lds
    s_add_u32 s92, s3, 4
    s_min_u32 s92, s92, 6
    s_mul_i32 s39, s92, 3072
    s_add_u32 m0, s39, 46080
    s_add_u32 s39, s92, 23
    s_mul_i32 s39, s39, 44032
    s_lshl_b32 s92, s89, 6
    s_add_u32 s83, s39, s92
    buffer_load_dwordx4 v7, s[60:63], s83 offen lds
    buffer_load_dwordx4 v8, s[60:63], s83 offen offset:1024 lds
    buffer_load_dwordx4 v9, s[60:63], s83 offen offset:2048 lds
    s_lshl_b32 s85, s5, 15
    s_add_u32 s85, s85, 67584
    v_add_u32 v246, s85, v11
    v_add_u32 v247, s85, v12
    ds_read_b64_tr_b16 a[128:129], v246 offset:0
    buffer_load_dwordx4 a[36:39], v4, s[72:75], s35 offen offset:1024 sc1
    ds_read_b64_tr_b16 a[130:131], v246 offset:1024
    ds_read_b64_tr_b16 a[132:133], v247 offset:0
    ds_read_b64_tr_b16 a[134:135], v247 offset:1024
    ds_read_b64_tr_b16 a[136:137], v246 offset:2048
    ds_read_b64_tr_b16 a[138:139], v246 offset:3072
    ds_read_b64_tr_b16 a[140:141], v247 offset:2048
    ds_read_b64_tr_b16 a[142:143], v247 offset:3072
    ds_read_b64_tr_b16 a[144:145], v246 offset:4096
    buffer_load_dwordx4 a[40:43], v4, s[72:75], s35 offen offset:2048 sc1
    ds_read_b64_tr_b16 a[146:147], v246 offset:5120
    ds_read_b64_tr_b16 a[148:149], v247 offset:4096
    ds_read_b64_tr_b16 a[150:151], v247 offset:5120
    ds_read_b64_tr_b16 a[152:153], v246 offset:6144
    ds_read_b64_tr_b16 a[154:155], v246 offset:7168
    ds_read_b64_tr_b16 a[156:157], v247 offset:6144
    ds_read_b64_tr_b16 a[158:159], v247 offset:7168
    ds_read_b64_tr_b16 a[160:161], v246 offset:8192
    buffer_load_dwordx4 a[44:47], v4, s[72:75], s35 offen offset:3072 sc1
    ds_read_b64_tr_b16 a[162:163], v246 offset:9216
    ds_read_b64_tr_b16 a[164:165], v247 offset:8192
    ds_read_b64_tr_b16 a[166:167], v247 offset:9216
    ds_read_b64_tr_b16 a[168:169], v246 offset:10240
    ds_read_b64_tr_b16 a[170:171], v246 offset:11264
    ds_read_b64_tr_b16 a[172:173], v247 offset:10240
    ds_read_b64_tr_b16 a[174:175], v247 offset:11264
    ds_read_b64_tr_b16 a[176:177], v246 offset:12288
    s_add_u32 s35, s30, 3
    s_and_b32 s35, s35, 7
    s_lshl_b32 s35, s35, 12
    s_add_u32 s35, s35, s16
    buffer_load_dwordx4 a[48:51], v4, s[72:75], s35 offen offset:0 sc1
    ds_read_b64_tr_b16 a[178:179], v246 offset:13312
    ds_read_b64_tr_b16 a[180:181], v247 offset:12288
    ds_read_b64_tr_b16 a[182:183], v247 offset:13312
    ds_read_b64_tr_b16 a[184:185], v246 offset:14336
    ds_read_b64_tr_b16 a[186:187], v246 offset:15360
    ds_read_b64_tr_b16 a[188:189], v247 offset:14336
    ds_read_b64_tr_b16 a[190:191], v247 offset:15360
    ds_read_b64_tr_b16 a[192:193], v246 offset:16384
    buffer_load_dwordx4 a[52:55], v4, s[72:75], s35 offen offset:1024 sc1
    ds_read_b64_tr_b16 a[194:195], v246 offset:17408
    ds_read_b64_tr_b16 a[196:197], v247 offset:16384
    ds_read_b64_tr_b16 a[198:199], v247 offset:17408
    ds_read_b64_tr_b16 a[200:201], v246 offset:18432
    ds_read_b64_tr_b16 a[202:203], v246 offset:19456
    ds_read_b64_tr_b16 a[204:205], v247 offset:18432
    ds_read_b64_tr_b16 a[206:207], v247 offset:19456
    ds_read_b64_tr_b16 a[208:209], v246 offset:20480
    buffer_load_dwordx4 a[56:59], v4, s[72:75], s35 offen offset:2048 sc1
    ds_read_b64_tr_b16 a[210:211], v246 offset:21504
    ds_read_b64_tr_b16 a[212:213], v247 offset:20480
    ds_read_b64_tr_b16 a[214:215], v247 offset:21504
    ds_read_b64_tr_b16 a[216:217], v246 offset:22528
    ds_read_b64_tr_b16 a[218:219], v246 offset:23552
    ds_read_b64_tr_b16 a[220:221], v247 offset:22528
    ds_read_b64_tr_b16 a[222:223], v247 offset:23552
    ds_read_b64_tr_b16 a[224:225], v246 offset:24576
    buffer_load_dwordx4 a[60:63], v4, s[72:75], s35 offen offset:3072 sc1
    ds_read_b64_tr_b16 a[226:227], v246 offset:25600
    ds_read_b64_tr_b16 a[228:229], v247 offset:24576
    ds_read_b64_tr_b16 a[230:231], v247 offset:25600
    ds_read_b64_tr_b16 a[232:233], v246 offset:26624
    ds_read_b64_tr_b16 a[234:235], v246 offset:27648
    ds_read_b64_tr_b16 a[236:237], v247 offset:26624
    ds_read_b64_tr_b16 a[238:239], v247 offset:27648
    ds_read_b64_tr_b16 a[240:241], v246 offset:28672
    s_add_u32 s35, s30, 4
    s_and_b32 s35, s35, 7
    s_lshl_b32 s35, s35, 12
    s_add_u32 s35, s35, s16
    buffer_load_dwordx4 a[64:67], v4, s[72:75], s35 offen offset:0 sc1
    ds_read_b64_tr_b16 a[242:243], v246 offset:29696
    ds_read_b64_tr_b16 a[244:245], v247 offset:28672
    ds_read_b64_tr_b16 a[246:247], v247 offset:29696
    ds_read_b64_tr_b16 a[248:249], v246 offset:30720
    ds_read_b64_tr_b16 a[250:251], v246 offset:31744
    ds_read_b64_tr_b16 a[252:253], v247 offset:30720
    ds_read_b64_tr_b16 a[254:255], v247 offset:31744
    s_waitcnt vmcnt(41)
    s_waitcnt lgkmcnt(0)
    s_barrier
    v_lshlrev_b32 v195, 3, v2
    v_lshl_add_u32 v195, v3, 11, v195
    buffer_load_dwordx2 v[212:213], v195, s[72:75], s17 offen offset:0 sc1
    buffer_load_dwordx2 v[214:215], v195, s[72:75], s17 offen offset:256 sc1
    buffer_load_dwordx2 v[216:217], v195, s[72:75], s17 offen offset:512 sc1
    buffer_load_dwordx2 v[218:219], v195, s[72:75], s17 offen offset:768 sc1
    buffer_load_dwordx2 v[220:221], v195, s[72:75], s17 offen offset:1024 sc1
    buffer_load_dwordx2 v[222:223], v195, s[72:75], s17 offen offset:1280 sc1
    buffer_load_dwordx2 v[224:225], v195, s[72:75], s17 offen offset:1536 sc1
    buffer_load_dwordx2 v[226:227], v195, s[72:75], s17 offen offset:1792 sc1
    v_mov_b32 v192, v13
    v_add_u32 v193, 65536, v13
    v_add_u32 v194, 131072, v13
    v_mov_b32 v200, 0
    v_mov_b32 v201, 0
    v_mov_b32 v202, 0
    v_mov_b32 v203, 0
    v_mov_b32 v204, 0
    v_mov_b32 v205, 0
    ds_read_b64_tr_b16 v[64:65], v194 offset:2048
    ds_read_b64_tr_b16 v[66:67], v194 offset:3584
    ds_read_b64_tr_b16 v[68:69], v194 offset:2112
    ds_read_b64_tr_b16 v[70:71], v194 offset:3648
    ds_read_b64_tr_b16 v[72:73], v194 offset:2176
    ds_read_b64_tr_b16 v[74:75], v194 offset:3712
    ds_read_b64_tr_b16 v[76:77], v194 offset:5120
    ds_read_b64_tr_b16 v[78:79], v194 offset:6656
    ds_read_b64_tr_b16 v[80:81], v194 offset:5184
    ds_read_b64_tr_b16 v[82:83], v194 offset:6720
    ds_read_b64_tr_b16 v[84:85], v194 offset:5248
    ds_read_b64_tr_b16 v[86:87], v194 offset:6784
    s_waitcnt vmcnt(32) lgkmcnt(6)
    v_mfma_f32_32x32x16_bf16 v[144:159], v[64:67], a[0:3], 0
    ds_read_b64_tr_b16 v[88:89], v194 offset:8192
    ds_read_b64_tr_b16 v[90:91], v194 offset:9728
    v_mfma_f32_32x32x16_bf16 v[160:175], v[68:71], a[0:3], 0
    ds_read_b64_tr_b16 v[92:93], v194 offset:8256
    ds_read_b64_tr_b16 v[94:95], v194 offset:9792
    v_mfma_f32_32x32x16_bf16 v[176:191], v[72:75], a[0:3], 0
    ds_read_b64_tr_b16 v[96:97], v194 offset:8320
    ds_read_b64_tr_b16 v[98:99], v194 offset:9856
    buffer_load_dwordx4 a[68:71], v4, s[72:75], s35 offen offset:1024 sc1
    s_waitcnt vmcnt(32) lgkmcnt(6)
    v_mfma_f32_32x32x16_bf16 v[144:159], v[76:79], a[4:7], v[144:159]
    ds_read_b64_tr_b16 v[100:101], v194 offset:11264
    ds_read_b64_tr_b16 v[102:103], v194 offset:12800
    v_mfma_f32_32x32x16_bf16 v[160:175], v[80:83], a[4:7], v[160:175]
    ds_read_b64_tr_b16 v[104:105], v194 offset:11328
    ds_read_b64_tr_b16 v[106:107], v194 offset:12864
    v_mfma_f32_32x32x16_bf16 v[176:191], v[84:87], a[4:7], v[176:191]
    ds_read_b64_tr_b16 v[108:109], v194 offset:11392
    ds_read_b64_tr_b16 v[110:111], v194 offset:12928
    buffer_load_dwordx4 a[72:75], v4, s[72:75], s35 offen offset:2048 sc1
    s_waitcnt vmcnt(32) lgkmcnt(6)
    v_mfma_f32_32x32x16_bf16 v[144:159], v[88:91], a[8:11], v[144:159]
    ds_read_b64_tr_b16 v[112:113], v194 offset:14336
    ds_read_b64_tr_b16 v[114:115], v194 offset:15872
    v_mfma_f32_32x32x16_bf16 v[160:175], v[92:95], a[8:11], v[160:175]
    ds_read_b64_tr_b16 v[116:117], v194 offset:14400
    ds_read_b64_tr_b16 v[118:119], v194 offset:15936
    v_mfma_f32_32x32x16_bf16 v[176:191], v[96:99], a[8:11], v[176:191]
    ds_read_b64_tr_b16 v[120:121], v194 offset:14464
    ds_read_b64_tr_b16 v[122:123], v194 offset:16000
    buffer_load_dwordx4 a[76:79], v4, s[72:75], s35 offen offset:3072 sc1
    s_waitcnt vmcnt(32) lgkmcnt(6)
    v_mfma_f32_32x32x16_bf16 v[144:159], v[100:103], a[12:15], v[144:159]
    ds_read_b64_tr_b16 v[124:125], v194 offset:17408
    ds_read_b64_tr_b16 v[126:127], v194 offset:18944
    v_mfma_f32_32x32x16_bf16 v[160:175], v[104:107], a[12:15], v[160:175]
    ds_read_b64_tr_b16 v[128:129], v194 offset:17472
    ds_read_b64_tr_b16 v[130:131], v194 offset:19008
    v_mfma_f32_32x32x16_bf16 v[176:191], v[108:111], a[12:15], v[176:191]
    ds_read_b64_tr_b16 v[132:133], v194 offset:17536
    ds_read_b64_tr_b16 v[134:135], v194 offset:19072
    s_add_u32 s35, s30, 5
    s_and_b32 s35, s35, 7
    s_lshl_b32 s35, s35, 12
    s_add_u32 s35, s35, s16
    buffer_load_dwordx4 a[80:83], v4, s[72:75], s35 offen offset:0 sc1
    s_cmp_lg_u32 s3, 0
    s_cbranch_scc1 L_cb_56
    v_dot2c_f32_bf16 v200, s80, v64
    v_dot2c_f32_bf16 v201, s80, v65
    v_dot2c_f32_bf16 v200, s80, v66
    v_dot2c_f32_bf16 v201, s80, v67
    v_dot2c_f32_bf16 v202, s80, v68
    v_dot2c_f32_bf16 v203, s80, v69
    v_dot2c_f32_bf16 v202, s80, v70
    v_dot2c_f32_bf16 v203, s80, v71
    v_dot2c_f32_bf16 v204, s80, v72
    v_dot2c_f32_bf16 v205, s80, v73
    v_dot2c_f32_bf16 v204, s80, v74
    v_dot2c_f32_bf16 v205, s80, v75
    v_dot2c_f32_bf16 v200, s80, v76
    v_dot2c_f32_bf16 v201, s80, v77
    v_dot2c_f32_bf16 v200, s80, v78
    v_dot2c_f32_bf16 v201, s80, v79
    v_dot2c_f32_bf16 v202, s80, v80
    v_dot2c_f32_bf16 v203, s80, v81
    v_dot2c_f32_bf16 v202, s80, v82
    v_dot2c_f32_bf16 v203, s80, v83
    v_dot2c_f32_bf16 v204, s80, v84
    v_dot2c_f32_bf16 v205, s80, v85
    v_dot2c_f32_bf16 v204, s80, v86
    v_dot2c_f32_bf16 v205, s80, v87
    v_dot2c_f32_bf16 v200, s80, v88
    v_dot2c_f32_bf16 v201, s80, v89
    v_dot2c_f32_bf16 v200, s80, v90
    v_dot2c_f32_bf16 v201, s80, v91
    v_dot2c_f32_bf16 v202, s80, v92
    v_dot2c_f32_bf16 v203, s80, v93
    v_dot2c_f32_bf16 v202, s80, v94
    v_dot2c_f32_bf16 v203, s80, v95
    v_dot2c_f32_bf16 v204, s80, v96
    v_dot2c_f32_bf16 v205, s80, v97
    v_dot2c_f32_bf16 v204, s80, v98
    v_dot2c_f32_bf16 v205, s80, v99
    v_dot2c_f32_bf16 v200, s80, v100
    v_dot2c_f32_bf16 v201, s80, v101
    v_dot2c_f32_bf16 v200, s80, v102
    v_dot2c_f32_bf16 v201, s80, v103
    v_dot2c_f32_bf16 v202, s80, v104
    v_dot2c_f32_bf16 v203, s80, v105
    v_dot2c_f32_bf16 v202, s80, v106
    v_dot2c_f32_bf16 v203, s80, v107
    v_dot2c_f32_bf16 v204, s80, v108
    v_dot2c_f32_bf16 v205, s80, v109
    v_dot2c_f32_bf16 v204, s80, v110
    v_dot2c_f32_bf16 v205, s80, v111
L_cb_56:
    s_waitcnt vmcnt(32) lgkmcnt(6)
    v_mfma_f32_32x32x16_bf16 v[144:159], v[112:115], a[16:19], v[144:159]
    ds_read_b64_tr_b16 v[64:65], v194 offset:20480
    ds_read_b64_tr_b16 v[66:67], v194 offset:22016
    v_mfma_f32_32x32x16_bf16 v[160:175], v[116:119], a[16:19], v[160:175]
    ds_read_b64_tr_b16 v[68:69], v194 offset:20544
    ds_read_b64_tr_b16 v[70:71], v194 offset:22080
    v_mfma_f32_32x32x16_bf16 v[176:191], v[120:123], a[16:19], v[176:191]
    ds_read_b64_tr_b16 v[72:73], v194 offset:20608
    ds_read_b64_tr_b16 v[74:75], v194 offset:22144
    buffer_load_dwordx4 a[84:87], v4, s[72:75], s35 offen offset:1024 sc1
    s_waitcnt vmcnt(32) lgkmcnt(6)
    v_mfma_f32_32x32x16_bf16 v[144:159], v[124:127], a[20:23], v[144:159]
    ds_read_b64_tr_b16 v[76:77], v194 offset:23552
    ds_read_b64_tr_b16 v[78:79], v194 offset:25088
    v_mfma_f32_32x32x16_bf16 v[160:175], v[128:131], a[20:23], v[160:175]
    ds_read_b64_tr_b16 v[80:81], v194 offset:23616
    ds_read_b64_tr_b16 v[82:83], v194 offset:25152
    v_mfma_f32_32x32x16_bf16 v[176:191], v[132:135], a[20:23], v[176:191]
    ds_read_b64_tr_b16 v[84:85], v194 offset:23680
    ds_read_b64_tr_b16 v[86:87], v194 offset:25216
    buffer_load_dwordx4 a[88:91], v4, s[72:75], s35 offen offset:2048 sc1
    s_waitcnt vmcnt(32) lgkmcnt(6)
    v_mfma_f32_32x32x16_bf16 v[144:159], v[64:67], a[24:27], v[144:159]
    ds_read_b64_tr_b16 v[88:89], v192 offset:0
    ds_read_b64_tr_b16 v[90:91], v192 offset:1536
    v_mfma_f32_32x32x16_bf16 v[160:175], v[68:71], a[24:27], v[160:175]
    ds_read_b64_tr_b16 v[92:93], v192 offset:64
    ds_read_b64_tr_b16 v[94:95], v192 offset:1600
    v_mfma_f32_32x32x16_bf16 v[176:191], v[72:75], a[24:27], v[176:191]
    ds_read_b64_tr_b16 v[96:97], v192 offset:128
    ds_read_b64_tr_b16 v[98:99], v192 offset:1664
    buffer_load_dwordx4 a[92:95], v4, s[72:75], s35 offen offset:3072 sc1
    s_waitcnt vmcnt(32) lgkmcnt(6)
    v_mfma_f32_32x32x16_bf16 v[144:159], v[76:79], a[28:31], v[144:159]
    ds_read_b64_tr_b16 v[100:101], v192 offset:3072
    ds_read_b64_tr_b16 v[102:103], v192 offset:4608
    v_mfma_f32_32x32x16_bf16 v[160:175], v[80:83], a[28:31], v[160:175]
    ds_read_b64_tr_b16 v[104:105], v192 offset:3136
    ds_read_b64_tr_b16 v[106:107], v192 offset:4672
    v_mfma_f32_32x32x16_bf16 v[176:191], v[84:87], a[28:31], v[176:191]
    ds_read_b64_tr_b16 v[108:109], v192 offset:3200
    ds_read_b64_tr_b16 v[110:111], v192 offset:4736
    s_add_u32 s35, s30, 6
    s_and_b32 s35, s35, 7
    s_lshl_b32 s35, s35, 12
    s_add_u32 s35, s35, s16
    buffer_load_dwordx4 a[96:99], v4, s[72:75], s35 offen offset:0 sc1
    s_cmp_lg_u32 s3, 0
    s_cbranch_scc1 L_cb_57
    v_dot2c_f32_bf16 v200, s80, v112
    v_dot2c_f32_bf16 v201, s80, v113
    v_dot2c_f32_bf16 v200, s80, v114
    v_dot2c_f32_bf16 v201, s80, v115
    v_dot2c_f32_bf16 v202, s80, v116
    v_dot2c_f32_bf16 v203, s80, v117
    v_dot2c_f32_bf16 v202, s80, v118
    v_dot2c_f32_bf16 v203, s80, v119
    v_dot2c_f32_bf16 v204, s80, v120
    v_dot2c_f32_bf16 v205, s80, v121
    v_dot2c_f32_bf16 v204, s80, v122
    v_dot2c_f32_bf16 v205, s80, v123
    v_dot2c_f32_bf16 v200, s80, v124
    v_dot2c_f32_bf16 v201, s80, v125
    v_dot2c_f32_bf16 v200, s80, v126
    v_dot2c_f32_bf16 v201, s80, v127
    v_dot2c_f32_bf16 v202, s80, v128
    v_dot2c_f32_bf16 v203, s80, v129
    v_dot2c_f32_bf16 v202, s80, v130
    v_dot2c_f32_bf16 v203, s80, v131
    v_dot2c_f32_bf16 v204, s80, v132
    v_dot2c_f32_bf16 v205, s80, v133
    v_dot2c_f32_bf16 v204, s80, v134
    v_dot2c_f32_bf16 v205, s80, v135
    v_dot2c_f32_bf16 v200, s80, v64
    v_dot2c_f32_bf16 v201, s80, v65
    v_dot2c_f32_bf16 v200, s80, v66
    v_dot2c_f32_bf16 v201, s80, v67
    v_dot2c_f32_bf16 v202, s80, v68
    v_dot2c_f32_bf16 v203, s80, v69
    v_dot2c_f32_bf16 v202, s80, v70
    v_dot2c_f32_bf16 v203, s80, v71
    v_dot2c_f32_bf16 v204, s80, v72
    v_dot2c_f32_bf16 v205, s80, v73
    v_dot2c_f32_bf16 v204, s80, v74
    v_dot2c_f32_bf16 v205, s80, v75
    v_dot2c_f32_bf16 v200, s80, v76
    v_dot2c_f32_bf16 v201, s80, v77
    v_dot2c_f32_bf16 v200, s80, v78
    v_dot2c_f32_bf16 v201, s80, v79
    v_dot2c_f32_bf16 v202, s80, v80
    v_dot2c_f32_bf16 v203, s80, v81
    v_dot2c_f32_bf16 v202, s80, v82
    v_dot2c_f32_bf16 v203, s80, v83
    v_dot2c_f32_bf16 v204, s80, v84
    v_dot2c_f32_bf16 v205, s80, v85
    v_dot2c_f32_bf16 v204, s80, v86
    v_dot2c_f32_bf16 v205, s80, v87
L_cb_57:
    s_waitcnt vmcnt(30)
    s_barrier
    s_cmp_lg_u32 s3, 3
    s_cbranch_scc1 L_askip_58
    s_mov_b64 s[94:95], exec
    s_mov_b64 exec, 1
    s_and_b32 s97, s6, 3
    s_lshl_b32 s97, s97, 8
    s_add_u32 s97, s97, s19
    s_add_u32 s97, s97, 1707008
    v_mov_b32 v248, s97
    v_mov_b32 v249, 1
    buffer_atomic_add v249, v248, s[72:75], 0 offen
    s_mov_b64 exec, s[94:95]
L_askip_58:
    s_waitcnt vmcnt(32) lgkmcnt(6)
    v_mfma_f32_32x32x16_bf16 v[144:159], v[88:91], a[32:35], v[144:159]
    ds_read_b64_tr_b16 v[112:113], v192 offset:6144
    ds_read_b64_tr_b16 v[114:115], v192 offset:7680
    v_mfma_f32_32x32x16_bf16 v[160:175], v[92:95], a[32:35], v[160:175]
    ds_read_b64_tr_b16 v[116:117], v192 offset:6208
    ds_read_b64_tr_b16 v[118:119], v192 offset:7744
    v_mfma_f32_32x32x16_bf16 v[176:191], v[96:99], a[32:35], v[176:191]
    ds_read_b64_tr_b16 v[120:121], v192 offset:6272
    ds_read_b64_tr_b16 v[122:123], v192 offset:7808
    buffer_load_dwordx4 a[100:103], v4, s[72:75], s35 offen offset:1024 sc1
    s_waitcnt vmcnt(24) lgkmcnt(6)
    v_mfma_f32_32x32x16_bf16 v[144:159], v[100:103], a[36:39], v[144:159]
    ds_read_b64_tr_b16 v[124:125], v192 offset:9216
    ds_read_b64_tr_b16 v[126:127], v192 offset:10752
    v_mfma_f32_32x32x16_bf16 v[160:175], v[104:107], a[36:39], v[160:175]
    ds_read_b64_tr_b16 v[128:129], v192 offset:9280
    ds_read_b64_tr_b16 v[130:131], v192 offset:10816
    v_mfma_f32_32x32x16_bf16 v[176:191], v[108:111], a[36:39], v[176:191]
    ds_read_b64_tr_b16 v[132:133], v192 offset:9344
    ds_read_b64_tr_b16 v[134:135], v192 offset:10880
    buffer_load_dwordx4 a[104:107], v4, s[72:75], s35 offen offset:2048 sc1
    s_waitcnt vmcnt(24) lgkmcnt(6)
    v_mfma_f32_32x32x16_bf16 v[144:159], v[112:115], a[40:43], v[144:159]
    ds_read_b64_tr_b16 v[64:65], v192 offset:12288
    ds_read_b64_tr_b16 v[66:67], v192 offset:13824
    v_mfma_f32_32x32x16_bf16 v[160:175], v[116:119], a[40:43], v[160:175]
    ds_read_b64_tr_b16 v[68:69], v192 offset:12352
    ds_read_b64_tr_b16 v[70:71], v192 offset:13888
    v_mfma_f32_32x32x16_bf16 v[176:191], v[120:123], a[40:43], v[176:191]
    ds_read_b64_tr_b16 v[72:73], v192 offset:12416
    ds_read_b64_tr_b16 v[74:75], v192 offset:13952
    buffer_load_dwordx4 a[108:111], v4, s[72:75], s35 offen offset:3072 sc1
    s_waitcnt vmcnt(24) lgkmcnt(6)
    v_mfma_f32_32x32x16_bf16 v[144:159], v[124:127], a[44:47], v[144:159]
    ds_read_b64_tr_b16 v[76:77], v192 offset:15360
    ds_read_b64_tr_b16 v[78:79], v192 offset:16896
    v_mfma_f32_32x32x16_bf16 v[160:175], v[128:131], a[44:47], v[160:175]
    ds_read_b64_tr_b16 v[80:81], v192 offset:15424
    ds_read_b64_tr_b16 v[82:83], v192 offset:16960
    v_mfma_f32_32x32x16_bf16 v[176:191], v[132:135], a[44:47], v[176:191]
    ds_read_b64_tr_b16 v[84:85], v192 offset:15488
    ds_read_b64_tr_b16 v[86:87], v192 offset:17024
    s_add_u32 s35, s30, 7
    s_and_b32 s35, s35, 7
    s_lshl_b32 s35, s35, 12
    s_add_u32 s35, s35, s16
    buffer_load_dwordx4 a[112:115], v4, s[72:75], s35 offen offset:0 sc1
    s_cmp_lg_u32 s3, 1
    s_cbranch_scc1 L_cb_59
    v_dot2c_f32_bf16 v200, s80, v88
    v_dot2c_f32_bf16 v201, s80, v89
    v_dot2c_f32_bf16 v200, s80, v90
    v_dot2c_f32_bf16 v201, s80, v91
    v_dot2c_f32_bf16 v202, s80, v92
    v_dot2c_f32_bf16 v203, s80, v93
    v_dot2c_f32_bf16 v202, s80, v94
    v_dot2c_f32_bf16 v203, s80, v95
    v_dot2c_f32_bf16 v204, s80, v96
    v_dot2c_f32_bf16 v205, s80, v97
    v_dot2c_f32_bf16 v204, s80, v98
    v_dot2c_f32_bf16 v205, s80, v99
    v_dot2c_f32_bf16 v200, s80, v100
    v_dot2c_f32_bf16 v201, s80, v101
    v_dot2c_f32_bf16 v200, s80, v102
    v_dot2c_f32_bf16 v201, s80, v103
    v_dot2c_f32_bf16 v202, s80, v104
    v_dot2c_f32_bf16 v203, s80, v105
    v_dot2c_f32_bf16 v202, s80, v106
    v_dot2c_f32_bf16 v203, s80, v107
    v_dot2c_f32_bf16 v204, s80, v108
    v_dot2c_f32_bf16 v205, s80, v109
    v_dot2c_f32_bf16 v204, s80, v110
    v_dot2c_f32_bf16 v205, s80, v111
    v_dot2c_f32_bf16 v200, s80, v112
    v_dot2c_f32_bf16 v201, s80, v113
    v_dot2c_f32_bf16 v200, s80, v114
    v_dot2c_f32_bf16 v201, s80, v115
    v_dot2c_f32_bf16 v202, s80, v116
    v_dot2c_f32_bf16 v203, s80, v117
    v_dot2c_f32_bf16 v202, s80, v118
    v_dot2c_f32_bf16 v203, s80, v119
    v_dot2c_f32_bf16 v204, s80, v120
    v_dot2c_f32_bf16 v205, s80, v121
    v_dot2c_f32_bf16 v204, s80, v122
    v_dot2c_f32_bf16 v205, s80, v123
    v_dot2c_f32_bf16 v200, s80, v124
    v_dot2c_f32_bf16 v201, s80, v125
    v_dot2c_f32_bf16 v200, s80, v126
    v_dot2c_f32_bf16 v201, s80, v127
    v_dot2c_f32_bf16 v202, s80, v128
    v_dot2c_f32_bf16 v203, s80, v129
    v_dot2c_f32_bf16 v202, s80, v130
    v_dot2c_f32_bf16 v203, s80, v131
    v_dot2c_f32_bf16 v204, s80, v132
    v_dot2c_f32_bf16 v205, s80, v133
    v_dot2c_f32_bf16 v204, s80, v134
    v_dot2c_f32_bf16 v205, s80, v135
L_cb_59:
    s_waitcnt vmcnt(24) lgkmcnt(6)
    v_mfma_f32_32x32x16_bf16 v[144:159], v[64:67], a[48:51], v[144:159]
    ds_read_b64_tr_b16 v[88:89], v192 offset:18432
    ds_read_b64_tr_b16 v[90:91], v192 offset:19968
    v_mfma_f32_32x32x16_bf16 v[160:175], v[68:71], a[48:51], v[160:175]
    ds_read_b64_tr_b16 v[92:93], v192 offset:18496
    ds_read_b64_tr_b16 v[94:95], v192 offset:20032
    v_mfma_f32_32x32x16_bf16 v[176:191], v[72:75], a[48:51], v[176:191]
    ds_read_b64_tr_b16 v[96:97], v192 offset:18560
    ds_read_b64_tr_b16 v[98:99], v192 offset:20096
    buffer_load_dwordx4 a[116:119], v4, s[72:75], s35 offen offset:1024 sc1
    s_waitcnt vmcnt(24) lgkmcnt(6)
    v_mfma_f32_32x32x16_bf16 v[144:159], v[76:79], a[52:55], v[144:159]
    ds_read_b64_tr_b16 v[100:101], v192 offset:21504
    ds_read_b64_tr_b16 v[102:103], v192 offset:23040
    v_mfma_f32_32x32x16_bf16 v[160:175], v[80:83], a[52:55], v[160:175]
    ds_read_b64_tr_b16 v[104:105], v192 offset:21568
    ds_read_b64_tr_b16 v[106:107], v192 offset:23104
    v_mfma_f32_32x32x16_bf16 v[176:191], v[84:87], a[52:55], v[176:191]
    ds_read_b64_tr_b16 v[108:109], v192 offset:21632
    ds_read_b64_tr_b16 v[110:111], v192 offset:23168
    buffer_load_dwordx4 a[120:123], v4, s[72:75], s35 offen offset:2048 sc1
    s_waitcnt vmcnt(24) lgkmcnt(6)
    v_mfma_f32_32x32x16_bf16 v[144:159], v[88:91], a[56:59], v[144:159]
    ds_read_b64_tr_b16 v[112:113], v192 offset:24576
    ds_read_b64_tr_b16 v[114:115], v192 offset:26112
    v_mfma_f32_32x32x16_bf16 v[160:175], v[92:95], a[56:59], v[160:175]
    ds_read_b64_tr_b16 v[116:117], v192 offset:24640
    ds_read_b64_tr_b16 v[118:119], v192 offset:26176
    v_mfma_f32_32x32x16_bf16 v[176:191], v[96:99], a[56:59], v[176:191]
    ds_read_b64_tr_b16 v[120:121], v192 offset:24704
    ds_read_b64_tr_b16 v[122:123], v192 offset:26240
    buffer_load_dwordx4 a[124:127], v4, s[72:75], s35 offen offset:3072 sc1
    s_waitcnt vmcnt(24) lgkmcnt(6)
    v_mfma_f32_32x32x16_bf16 v[144:159], v[100:103], a[60:63], v[144:159]
    ds_read_b64_tr_b16 v[124:125], v192 offset:27648
    ds_read_b64_tr_b16 v[126:127], v192 offset:29184
    v_mfma_f32_32x32x16_bf16 v[160:175], v[104:107], a[60:63], v[160:175]
    ds_read_b64_tr_b16 v[128:129], v192 offset:27712
    ds_read_b64_tr_b16 v[130:131], v192 offset:29248
    v_mfma_f32_32x32x16_bf16 v[176:191], v[108:111], a[60:63], v[176:191]
    ds_read_b64_tr_b16 v[132:133], v192 offset:27776
    ds_read_b64_tr_b16 v[134:135], v192 offset:29312
    s_add_u32 m0, s12, 116736
    s_add_u32 s83, s33, 753664
    buffer_load_dwordx4 v5, s[64:67], s83 offen lds
    s_cmp_lg_u32 s3, 1
    s_cbranch_scc1 L_cb_60
    v_dot2c_f32_bf16 v200, s80, v64
    v_dot2c_f32_bf16 v201, s80, v65
    v_dot2c_f32_bf16 v200, s80, v66
    v_dot2c_f32_bf16 v201, s80, v67
    v_dot2c_f32_bf16 v202, s80, v68
    v_dot2c_f32_bf16 v203, s80, v69
    v_dot2c_f32_bf16 v202, s80, v70
    v_dot2c_f32_bf16 v203, s80, v71
    v_dot2c_f32_bf16 v204, s80, v72
    v_dot2c_f32_bf16 v205, s80, v73
    v_dot2c_f32_bf16 v204, s80, v74
    v_dot2c_f32_bf16 v205, s80, v75
    v_dot2c_f32_bf16 v200, s80, v76
    v_dot2c_f32_bf16 v201, s80, v77
    v_dot2c_f32_bf16 v200, s80, v78
    v_dot2c_f32_bf16 v201, s80, v79
    v_dot2c_f32_bf16 v202, s80, v80
    v_dot2c_f32_bf16 v203, s80, v81
    v_dot2c_f32_bf16 v202, s80, v82
    v_dot2c_f32_bf16 v203, s80, v83
    v_dot2c_f32_bf16 v204, s80, v84
    v_dot2c_f32_bf16 v205, s80, v85
    v_dot2c_f32_bf16 v204, s80, v86
    v_dot2c_f32_bf16 v205, s80, v87
    v_dot2c_f32_bf16 v200, s80, v88
    v_dot2c_f32_bf16 v201, s80, v89
    v_dot2c_f32_bf16 v200, s80, v90
    v_dot2c_f32_bf16 v201, s80, v91
    v_dot2c_f32_bf16 v202, s80, v92
    v_dot2c_f32_bf16 v203, s80, v93
    v_dot2c_f32_bf16 v202, s80, v94
    v_dot2c_f32_bf16 v203, s80, v95
    v_dot2c_f32_bf16 v204, s80, v96
    v_dot2c_f32_bf16 v205, s80, v97
    v_dot2c_f32_bf16 v204, s80, v98
    v_dot2c_f32_bf16 v205, s80, v99
    v_dot2c_f32_bf16 v200, s80, v100
    v_dot2c_f32_bf16 v201, s80, v101
    v_dot2c_f32_bf16 v200, s80, v102
    v_dot2c_f32_bf16 v201, s80, v103
    v_dot2c_f32_bf16 v202, s80, v104
    v_dot2c_f32_bf16 v203, s80, v105
    v_dot2c_f32_bf16 v202, s80, v106
    v_dot2c_f32_bf16 v203, s80, v107
    v_dot2c_f32_bf16 v204, s80, v108
    v_dot2c_f32_bf16 v205, s80, v109
    v_dot2c_f32_bf16 v204, s80, v110
    v_dot2c_f32_bf16 v205, s80, v111
L_cb_60:
    s_waitcnt vmcnt(24) lgkmcnt(6)
    v_mfma_f32_32x32x16_bf16 v[144:159], v[112:115], a[64:67], v[144:159]
    ds_read_b64_tr_b16 v[64:65], v192 offset:30720
    ds_read_b64_tr_b16 v[66:67], v192 offset:32256
    v_mfma_f32_32x32x16_bf16 v[160:175], v[116:119], a[64:67], v[160:175]
    ds_read_b64_tr_b16 v[68:69], v192 offset:30784
    ds_read_b64_tr_b16 v[70:71], v192 offset:32320
    v_mfma_f32_32x32x16_bf16 v[176:191], v[120:123], a[64:67], v[176:191]
    ds_read_b64_tr_b16 v[72:73], v192 offset:30848
    ds_read_b64_tr_b16 v[74:75], v192 offset:32384
    buffer_load_dwordx4 v136, s[64:67], s83 offen offset:1024 lds
    s_waitcnt vmcnt(16) lgkmcnt(6)
    v_mfma_f32_32x32x16_bf16 v[144:159], v[124:127], a[68:71], v[144:159]
    ds_read_b64_tr_b16 v[76:77], v192 offset:33792
    ds_read_b64_tr_b16 v[78:79], v192 offset:35328
    v_mfma_f32_32x32x16_bf16 v[160:175], v[128:131], a[68:71], v[160:175]
    ds_read_b64_tr_b16 v[80:81], v192 offset:33856
    ds_read_b64_tr_b16 v[82:83], v192 offset:35392
    v_mfma_f32_32x32x16_bf16 v[176:191], v[132:135], a[68:71], v[176:191]
    ds_read_b64_tr_b16 v[84:85], v192 offset:33920
    ds_read_b64_tr_b16 v[86:87], v192 offset:35456
    buffer_load_dwordx4 v137, s[64:67], s83 offen offset:2048 lds
    s_waitcnt vmcnt(16) lgkmcnt(6)
    v_mfma_f32_32x32x16_bf16 v[144:159], v[64:67], a[72:75], v[144:159]
    ds_read_b64_tr_b16 v[88:89], v192 offset:36864
    ds_read_b64_tr_b16 v[90:91], v192 offset:38400
    v_mfma_f32_32x32x16_bf16 v[160:175], v[68:71], a[72:75], v[160:175]
    ds_read_b64_tr_b16 v[92:93], v192 offset:36928
    ds_read_b64_tr_b16 v[94:95], v192 offset:38464
    v_mfma_f32_32x32x16_bf16 v[176:191], v[72:75], a[72:75], v[176:191]
    ds_read_b64_tr_b16 v[96:97], v192 offset:36992
    ds_read_b64_tr_b16 v[98:99], v192 offset:38528
    buffer_load_dwordx4 v138, s[64:67], s83 offen offset:3072 lds
    s_waitcnt vmcnt(35)
    s_barrier
    s_waitcnt vmcnt(16) lgkmcnt(6)
    v_mfma_f32_32x32x16_bf16 v[144:159], v[76:79], a[76:79], v[144:159]
    ds_read_b64_tr_b16 v[100:101], v192 offset:39936
    ds_read_b64_tr_b16 v[102:103], v192 offset:41472
    v_mfma_f32_32x32x16_bf16 v[160:175], v[80:83], a[76:79], v[160:175]
    ds_read_b64_tr_b16 v[104:105], v192 offset:40000
    ds_read_b64_tr_b16 v[106:107], v192 offset:41536
    v_mfma_f32_32x32x16_bf16 v[176:191], v[84:87], a[76:79], v[176:191]
    ds_read_b64_tr_b16 v[108:109], v192 offset:40064
    ds_read_b64_tr_b16 v[110:111], v192 offset:41600
    s_add_u32 m0, s12, 67584
    s_add_u32 s83, s33, 0
    buffer_load_dwordx4 v5, s[64:67], s83 offen lds
    s_cmp_lg_u32 s3, 2
    s_cbranch_scc1 L_cb_61
    v_dot2c_f32_bf16 v200, s80, v112
    v_dot2c_f32_bf16 v201, s80, v113
    v_dot2c_f32_bf16 v200, s80, v114
    v_dot2c_f32_bf16 v201, s80, v115
    v_dot2c_f32_bf16 v202, s80, v116
    v_dot2c_f32_bf16 v203, s80, v117
    v_dot2c_f32_bf16 v202, s80, v118
    v_dot2c_f32_bf16 v203, s80, v119
    v_dot2c_f32_bf16 v204, s80, v120
    v_dot2c_f32_bf16 v205, s80, v121
    v_dot2c_f32_bf16 v204, s80, v122
    v_dot2c_f32_bf16 v205, s80, v123
    v_dot2c_f32_bf16 v200, s80, v124
    v_dot2c_f32_bf16 v201, s80, v125
    v_dot2c_f32_bf16 v200, s80, v126
    v_dot2c_f32_bf16 v201, s80, v127
    v_dot2c_f32_bf16 v202, s80, v128
    v_dot2c_f32_bf16 v203, s80, v129
    v_dot2c_f32_bf16 v202, s80, v130
    v_dot2c_f32_bf16 v203, s80, v131
    v_dot2c_f32_bf16 v204, s80, v132
    v_dot2c_f32_bf16 v205, s80, v133
    v_dot2c_f32_bf16 v204, s80, v134
    v_dot2c_f32_bf16 v205, s80, v135
    v_dot2c_f32_bf16 v200, s80, v64
    v_dot2c_f32_bf16 v201, s80, v65
    v_dot2c_f32_bf16 v200, s80, v66
    v_dot2c_f32_bf16 v201, s80, v67
    v_dot2c_f32_bf16 v202, s80, v68
    v_dot2c_f32_bf16 v203, s80, v69
    v_dot2c_f32_bf16 v202, s80, v70
    v_dot2c_f32_bf16 v203, s80, v71
    v_dot2c_f32_bf16 v204, s80, v72
    v_dot2c_f32_bf16 v205, s80, v73
    v_dot2c_f32_bf16 v204, s80, v74
    v_dot2c_f32_bf16 v205, s80, v75
    v_dot2c_f32_bf16 v200, s80, v76
    v_dot2c_f32_bf16 v201, s80, v77
    v_dot2c_f32_bf16 v200, s80, v78
    v_dot2c_f32_bf16 v201, s80, v79
    v_dot2c_f32_bf16 v202, s80, v80
    v_dot2c_f32_bf16 v203, s80, v81
    v_dot2c_f32_bf16 v202, s80, v82
    v_dot2c_f32_bf16 v203, s80, v83
    v_dot2c_f32_bf16 v204, s80, v84
    v_dot2c_f32_bf16 v205, s80, v85
    v_dot2c_f32_bf16 v204, s80, v86
    v_dot2c_f32_bf16 v205, s80, v87
L_cb_61:
    s_waitcnt vmcnt(16) lgkmcnt(6)
    v_mfma_f32_32x32x16_bf16 v[144:159], v[88:91], a[80:83], v[144:159]
    ds_read_b64_tr_b16 v[112:113], v192 offset:43008
    ds_read_b64_tr_b16 v[114:115], v192 offset:44544
    v_mfma_f32_32x32x16_bf16 v[160:175], v[92:95], a[80:83], v[160:175]
    ds_read_b64_tr_b16 v[116:117], v192 offset:43072
    ds_read_b64_tr_b16 v[118:119], v192 offset:44608
    v_mfma_f32_32x32x16_bf16 v[176:191], v[96:99], a[80:83], v[176:191]
    ds_read_b64_tr_b16 v[120:121], v192 offset:43136
    ds_read_b64_tr_b16 v[122:123], v192 offset:44672
    buffer_load_dwordx4 v136, s[64:67], s83 offen offset:1024 lds
    s_waitcnt vmcnt(16) lgkmcnt(6)
    v_mfma_f32_32x32x16_bf16 v[144:159], v[100:103], a[84:87], v[144:159]
    ds_read_b64_tr_b16 v[124:125], v192 offset:46080
    ds_read_b64_tr_b16 v[126:127], v192 offset:47616
    v_mfma_f32_32x32x16_bf16 v[160:175], v[104:107], a[84:87], v[160:175]
    ds_read_b64_tr_b16 v[128:129], v192 offset:46144
    ds_read_b64_tr_b16 v[130:131], v192 offset:47680
    v_mfma_f32_32x32x16_bf16 v[176:191], v[108:111], a[84:87], v[176:191]
    ds_read_b64_tr_b16 v[132:133], v192 offset:46208
    ds_read_b64_tr_b16 v[134:135], v192 offset:47744
    buffer_load_dwordx4 v137, s[64:67], s83 offen offset:2048 lds
    s_cmp_lg_u32 s3, 3
    s_cbranch_scc1 L_piskip_62
    s_and_b32 s97, s6, 3
    s_lshl_b32 s97, s97, 8
    s_add_u32 s97, s97, s19
    s_add_u32 s97, s97, 1707008
    v_mov_b32 v250, s97
    v_mov_b32 v251, 8
    s_mov_b64 s[94:95], exec
    s_mov_b64 exec, 1
    buffer_load_dword v252, v250, s[72:75], 0 offen sc1
    s_mov_b64 exec, s[94:95]
L_piskip_62:
    s_waitcnt vmcnt(16) lgkmcnt(6)
    v_mfma_f32_32x32x16_bf16 v[144:159], v[112:115], a[88:91], v[144:159]
    ds_read_b64_tr_b16 v[64:65], v192 offset:49152
    ds_read_b64_tr_b16 v[66:67], v192 offset:50688
    v_mfma_f32_32x32x16_bf16 v[160:175], v[116:119], a[88:91], v[160:175]
    ds_read_b64_tr_b16 v[68:69], v192 offset:49216
    ds_read_b64_tr_b16 v[70:71], v192 offset:50752
    v_mfma_f32_32x32x16_bf16 v[176:191], v[120:123], a[88:91], v[176:191]
    ds_read_b64_tr_b16 v[72:73], v192 offset:49280
    ds_read_b64_tr_b16 v[74:75], v192 offset:50816
    buffer_load_dwordx4 v138, s[64:67], s83 offen offset:3072 lds
    s_waitcnt vmcnt(16) lgkmcnt(6)
    v_mfma_f32_32x32x16_bf16 v[144:159], v[124:127], a[92:95], v[144:159]
    ds_read_b64_tr_b16 v[76:77], v192 offset:52224
    ds_read_b64_tr_b16 v[78:79], v192 offset:53760
    v_mfma_f32_32x32x16_bf16 v[160:175], v[128:131], a[92:95], v[160:175]
    ds_read_b64_tr_b16 v[80:81], v192 offset:52288
    ds_read_b64_tr_b16 v[82:83], v192 offset:53824
    v_mfma_f32_32x32x16_bf16 v[176:191], v[132:135], a[92:95], v[176:191]
    ds_read_b64_tr_b16 v[84:85], v192 offset:52352
    ds_read_b64_tr_b16 v[86:87], v192 offset:53888
    s_add_u32 m0, s12, 83968
    s_add_u32 s83, s33, 393216
    buffer_load_dwordx4 v5, s[64:67], s83 offen lds
    s_cmp_lg_u32 s3, 2
    s_cbranch_scc1 L_cb_63
    v_dot2c_f32_bf16 v200, s80, v88
    v_dot2c_f32_bf16 v201, s80, v89
    v_dot2c_f32_bf16 v200, s80, v90
    v_dot2c_f32_bf16 v201, s80, v91
    v_dot2c_f32_bf16 v202, s80, v92
    v_dot2c_f32_bf16 v203, s80, v93
    v_dot2c_f32_bf16 v202, s80, v94
    v_dot2c_f32_bf16 v203, s80, v95
    v_dot2c_f32_bf16 v204, s80, v96
    v_dot2c_f32_bf16 v205, s80, v97
    v_dot2c_f32_bf16 v204, s80, v98
    v_dot2c_f32_bf16 v205, s80, v99
    v_dot2c_f32_bf16 v200, s80, v100
    v_dot2c_f32_bf16 v201, s80, v101
    v_dot2c_f32_bf16 v200, s80, v102
    v_dot2c_f32_bf16 v201, s80, v103
    v_dot2c_f32_bf16 v202, s80, v104
    v_dot2c_f32_bf16 v203, s80, v105
    v_dot2c_f32_bf16 v202, s80, v106
    v_dot2c_f32_bf16 v203, s80, v107
    v_dot2c_f32_bf16 v204, s80, v108
    v_dot2c_f32_bf16 v205, s80, v109
    v_dot2c_f32_bf16 v204, s80, v110
    v_dot2c_f32_bf16 v205, s80, v111
    v_dot2c_f32_bf16 v200, s80, v112
    v_dot2c_f32_bf16 v201, s80, v113
    v_dot2c_f32_bf16 v200, s80, v114
    v_dot2c_f32_bf16 v201, s80, v115
    v_dot2c_f32_bf16 v202, s80, v116
    v_dot2c_f32_bf16 v203, s80, v117
    v_dot2c_f32_bf16 v202, s80, v118
    v_dot2c_f32_bf16 v203, s80, v119
    v_dot2c_f32_bf16 v204, s80, v120
    v_dot2c_f32_bf16 v205, s80, v121
    v_dot2c_f32_bf16 v204, s80, v122
    v_dot2c_f32_bf16 v205, s80, v123
    v_dot2c_f32_bf16 v200, s80, v124
    v_dot2c_f32_bf16 v201, s80, v125
    v_dot2c_f32_bf16 v200, s80, v126
    v_dot2c_f32_bf16 v201, s80, v127
    v_dot2c_f32_bf16 v202, s80, v128
    v_dot2c_f32_bf16 v203, s80, v129
    v_dot2c_f32_bf16 v202, s80, v130
    v_dot2c_f32_bf16 v203, s80, v131
    v_dot2c_f32_bf16 v204, s80, v132
    v_dot2c_f32_bf16 v205, s80, v133
    v_dot2c_f32_bf16 v204, s80, v134
    v_dot2c_f32_bf16 v205, s80, v135
L_cb_63:
    s_waitcnt vmcnt(16) lgkmcnt(6)
    v_mfma_f32_32x32x16_bf16 v[144:159], v[64:67], a[96:99], v[144:159]
    ds_read_b64_tr_b16 v[88:89], v192 offset:55296
    ds_read_b64_tr_b16 v[90:91], v192 offset:56832
    v_mfma_f32_32x32x16_bf16 v[160:175], v[68:71], a[96:99], v[160:175]
    ds_read_b64_tr_b16 v[92:93], v192 offset:55360
    ds_read_b64_tr_b16 v[94:95], v192 offset:56896
    v_mfma_f32_32x32x16_bf16 v[176:191], v[72:75], a[96:99], v[176:191]
    ds_read_b64_tr_b16 v[96:97], v192 offset:55424
    ds_read_b64_tr_b16 v[98:99], v192 offset:56960
    buffer_load_dwordx4 v136, s[64:67], s83 offen offset:1024 lds
    s_waitcnt vmcnt(16) lgkmcnt(6)
    v_mfma_f32_32x32x16_bf16 v[144:159], v[76:79], a[100:103], v[144:159]
    ds_read_b64_tr_b16 v[100:101], v192 offset:58368
    ds_read_b64_tr_b16 v[102:103], v192 offset:59904
    v_mfma_f32_32x32x16_bf16 v[160:175], v[80:83], a[100:103], v[160:175]
    ds_read_b64_tr_b16 v[104:105], v192 offset:58432
    ds_read_b64_tr_b16 v[106:107], v192 offset:59968
    v_mfma_f32_32x32x16_bf16 v[176:191], v[84:87], a[100:103], v[176:191]
    ds_read_b64_tr_b16 v[108:109], v192 offset:58496
    ds_read_b64_tr_b16 v[110:111], v192 offset:60032
    buffer_load_dwordx4 v137, s[64:67], s83 offen offset:2048 lds
    s_waitcnt vmcnt(16) lgkmcnt(6)
    v_mfma_f32_32x32x16_bf16 v[144:159], v[88:91], a[104:107], v[144:159]
    ds_read_b64_tr_b16 v[112:113], v192 offset:61440
    ds_read_b64_tr_b16 v[114:115], v192 offset:62976
    v_mfma_f32_32x32x16_bf16 v[160:175], v[92:95], a[104:107], v[160:175]
    ds_read_b64_tr_b16 v[116:117], v192 offset:61504
    ds_read_b64_tr_b16 v[118:119], v192 offset:63040
    v_mfma_f32_32x32x16_bf16 v[176:191], v[96:99], a[104:107], v[176:191]
    ds_read_b64_tr_b16 v[120:121], v192 offset:61568
    ds_read_b64_tr_b16 v[122:123], v192 offset:63104
    buffer_load_dwordx4 v138, s[64:67], s83 offen offset:3072 lds
    s_waitcnt vmcnt(16) lgkmcnt(6)
    v_mfma_f32_32x32x16_bf16 v[144:159], v[100:103], a[108:111], v[144:159]
    ds_read_b64_tr_b16 v[124:125], v192 offset:64512
    ds_read_b64_tr_b16 v[126:127], v193 offset:512
    v_mfma_f32_32x32x16_bf16 v[160:175], v[104:107], a[108:111], v[160:175]
    ds_read_b64_tr_b16 v[128:129], v192 offset:64576
    ds_read_b64_tr_b16 v[130:131], v193 offset:576
    v_mfma_f32_32x32x16_bf16 v[176:191], v[108:111], a[108:111], v[176:191]
    ds_read_b64_tr_b16 v[132:133], v192 offset:64640
    ds_read_b64_tr_b16 v[134:135], v193 offset:640
    s_add_u32 m0, s12, 100352
    s_add_u32 s83, s33, 786432
    buffer_load_dwordx4 v5, s[64:67], s83 offen lds
    s_cmp_lg_u32 s3, 3
    s_cbranch_scc1 L_cb_64
    v_dot2c_f32_bf16 v200, s80, v64
    v_dot2c_f32_bf16 v201, s80, v65
    v_dot2c_f32_bf16 v200, s80, v66
    v_dot2c_f32_bf16 v201, s80, v67
    v_dot2c_f32_bf16 v202, s80, v68
    v_dot2c_f32_bf16 v203, s80, v69
    v_dot2c_f32_bf16 v202, s80, v70
    v_dot2c_f32_bf16 v203, s80, v71
    v_dot2c_f32_bf16 v204, s80, v72
    v_dot2c_f32_bf16 v205, s80, v73
    v_dot2c_f32_bf16 v204, s80, v74
    v_dot2c_f32_bf16 v205, s80, v75
    v_dot2c_f32_bf16 v200, s80, v76
    v_dot2c_f32_bf16 v201, s80, v77
    v_dot2c_f32_bf16 v200, s80, v78
    v_dot2c_f32_bf16 v201, s80, v79
    v_dot2c_f32_bf16 v202, s80, v80
    v_dot2c_f32_bf16 v203, s80, v81
    v_dot2c_f32_bf16 v202, s80, v82
    v_dot2c_f32_bf16 v203, s80, v83
    v_dot2c_f32_bf16 v204, s80, v84
    v_dot2c_f32_bf16 v205, s80, v85
    v_dot2c_f32_bf16 v204, s80, v86
    v_dot2c_f32_bf16 v205, s80, v87
    v_dot2c_f32_bf16 v200, s80, v88
    v_dot2c_f32_bf16 v201, s80, v89
    v_dot2c_f32_bf16 v200, s80, v90
    v_dot2c_f32_bf16 v201, s80, v91
    v_dot2c_f32_bf16 v202, s80, v92
    v_dot2c_f32_bf16 v203, s80, v93
    v_dot2c_f32_bf16 v202, s80, v94
    v_dot2c_f32_bf16 v203, s80, v95
    v_dot2c_f32_bf16 v204, s80, v96
    v_dot2c_f32_bf16 v205, s80, v97
    v_dot2c_f32_bf16 v204, s80, v98
    v_dot2c_f32_bf16 v205, s80, v99
    v_dot2c_f32_bf16 v200, s80, v100
    v_dot2c_f32_bf16 v201, s80, v101
    v_dot2c_f32_bf16 v200, s80, v102
    v_dot2c_f32_bf16 v201, s80, v103
    v_dot2c_f32_bf16 v202, s80, v104
    v_dot2c_f32_bf16 v203, s80, v105
    v_dot2c_f32_bf16 v202, s80, v106
    v_dot2c_f32_bf16 v203, s80, v107
    v_dot2c_f32_bf16 v204, s80, v108
    v_dot2c_f32_bf16 v205, s80, v109
    v_dot2c_f32_bf16 v204, s80, v110
    v_dot2c_f32_bf16 v205, s80, v111
L_cb_64:
    s_waitcnt vmcnt(16) lgkmcnt(6)
    v_mfma_f32_32x32x16_bf16 v[144:159], v[112:115], a[112:115], v[144:159]
    ds_read_b64_tr_b16 v[64:65], v194 offset:26624
    ds_read_b64_tr_b16 v[66:67], v194 offset:28160
    v_mfma_f32_32x32x16_bf16 v[160:175], v[116:119], a[112:115], v[160:175]
    ds_read_b64_tr_b16 v[68:69], v194 offset:26688
    ds_read_b64_tr_b16 v[70:71], v194 offset:28224
    v_mfma_f32_32x32x16_bf16 v[176:191], v[120:123], a[112:115], v[176:191]
    ds_read_b64_tr_b16 v[72:73], v194 offset:26752
    ds_read_b64_tr_b16 v[74:75], v194 offset:28288
    buffer_load_dwordx4 v136, s[64:67], s83 offen offset:1024 lds
    s_waitcnt vmcnt(16) lgkmcnt(6)
    v_mfma_f32_32x32x16_bf16 v[144:159], v[124:127], a[116:119], v[144:159]
    ds_read_b64_tr_b16 v[76:77], v194 offset:29696
    ds_read_b64_tr_b16 v[78:79], v194 offset:31232
    v_mfma_f32_32x32x16_bf16 v[160:175], v[128:131], a[116:119], v[160:175]
    ds_read_b64_tr_b16 v[80:81], v194 offset:29760
    ds_read_b64_tr_b16 v[82:83], v194 offset:31296
    v_mfma_f32_32x32x16_bf16 v[176:191], v[132:135], a[116:119], v[176:191]
    ds_read_b64_tr_b16 v[84:85], v194 offset:29824
    ds_read_b64_tr_b16 v[86:87], v194 offset:31360
    buffer_load_dwordx4 v137, s[64:67], s83 offen offset:2048 lds
    s_waitcnt vmcnt(16) lgkmcnt(6)
    v_mfma_f32_32x32x16_bf16 v[144:159], v[64:67], a[120:123], v[144:159]
    v_mfma_f32_32x32x16_bf16 v[160:175], v[68:71], a[120:123], v[160:175]
    v_mfma_f32_32x32x16_bf16 v[176:191], v[72:75], a[120:123], v[176:191]
    buffer_load_dwordx4 v138, s[64:67], s83 offen offset:3072 lds
    s_waitcnt vmcnt(16) lgkmcnt(0)
    v_mfma_f32_32x32x16_bf16 v[144:159], v[76:79], a[124:127], v[144:159]
    v_mfma_f32_32x32x16_bf16 v[160:175], v[80:83], a[124:127], v[160:175]
    v_mfma_f32_32x32x16_bf16 v[176:191], v[84:87], a[124:127], v[176:191]
    s_cmp_lg_u32 s3, 3
    s_cbranch_scc1 L_cb_65
    v_dot2c_f32_bf16 v200, s80, v112
    v_dot2c_f32_bf16 v201, s80, v113
    v_dot2c_f32_bf16 v200, s80, v114
    v_dot2c_f32_bf16 v201, s80, v115
    v_dot2c_f32_bf16 v202, s80, v116
    v_dot2c_f32_bf16 v203, s80, v117
    v_dot2c_f32_bf16 v202, s80, v118
    v_dot2c_f32_bf16 v203, s80, v119
    v_dot2c_f32_bf16 v204, s80, v120
    v_dot2c_f32_bf16 v205, s80, v121
    v_dot2c_f32_bf16 v204, s80, v122
    v_dot2c_f32_bf16 v205, s80, v123
    v_dot2c_f32_bf16 v200, s80, v124
    v_dot2c_f32_bf16 v201, s80, v125
    v_dot2c_f32_bf16 v200, s80, v126
    v_dot2c_f32_bf16 v201, s80, v127
    v_dot2c_f32_bf16 v202, s80, v128
    v_dot2c_f32_bf16 v203, s80, v129
    v_dot2c_f32_bf16 v202, s80, v130
    v_dot2c_f32_bf16 v203, s80, v131
    v_dot2c_f32_bf16 v204, s80, v132
    v_dot2c_f32_bf16 v205, s80, v133
    v_dot2c_f32_bf16 v204, s80, v134
    v_dot2c_f32_bf16 v205, s80, v135
    v_dot2c_f32_bf16 v200, s80, v64
    v_dot2c_f32_bf16 v201, s80, v65
    v_dot2c_f32_bf16 v200, s80, v66
    v_dot2c_f32_bf16 v201, s80, v67
    v_dot2c_f32_bf16 v202, s80, v68
    v_dot2c_f32_bf16 v203, s80, v69
    v_dot2c_f32_bf16 v202, s80, v70
    v_dot2c_f32_bf16 v203, s80, v71
    v_dot2c_f32_bf16 v204, s80, v72
    v_dot2c_f32_bf16 v205, s80, v73
    v_dot2c_f32_bf16 v204, s80, v74
    v_dot2c_f32_bf16 v205, s80, v75
    v_dot2c_f32_bf16 v200, s80, v76
    v_dot2c_f32_bf16 v201, s80, v77
    v_dot2c_f32_bf16 v200, s80, v78
    v_dot2c_f32_bf16 v201, s80, v79
    v_dot2c_f32_bf16 v202, s80, v80
    v_dot2c_f32_bf16 v203, s80, v81
    v_dot2c_f32_bf16 v202, s80, v82
    v_dot2c_f32_bf16 v203, s80, v83
    v_dot2c_f32_bf16 v204, s80, v84
    v_dot2c_f32_bf16 v205, s80, v85
    v_dot2c_f32_bf16 v204, s80, v86
    v_dot2c_f32_bf16 v205, s80, v87
L_cb_65:
    s_nop 2
    v_add_f32 v200, v200, v201
    v_mov_b32 v196, v200
    s_nop 1
    v_permlane32_swap_b32 v200, v196
    s_nop 0
    v_add_f32 v200, v200, v196
    v_add_f32 v202, v202, v203
    v_mov_b32 v196, v202
    s_nop 1
    v_permlane32_swap_b32 v202, v196
    s_nop 0
    v_add_f32 v202, v202, v196
    v_add_f32 v204, v204, v205
    v_mov_b32 v196, v204
    s_nop 1
    v_permlane32_swap_b32 v204, v196
    s_nop 0
    v_add_f32 v204, v204, v196
    s_mul_i32 s85, s3, 384
    v_lshl_add_u32 v196, v2, 2, s85
    v_add_u32 v196, 133120, v196
    ds_write_b32 v196, v200 offset:0
    ds_write_b32 v196, v202 offset:128
    ds_write_b32 v196, v204 offset:256
    s_waitcnt vmcnt(31)
    v_add_f32 v212, v212, v214
    v_add_f32 v213, v213, v215
    v_add_f32 v212, v212, v216
    v_add_f32 v213, v213, v217
    v_add_f32 v212, v212, v218
    v_add_f32 v213, v213, v219
    v_add_f32 v212, v212, v220
    v_add_f32 v213, v213, v221
    v_add_f32 v212, v212, v222
    v_add_f32 v213, v213, v223
    v_add_f32 v212, v212, v224
    v_add_f32 v213, v213, v225
    v_add_f32 v212, v212, v226
    v_add_f32 v213, v213, v227
    v_mov_b32 v199, v212
    v_mov_b32 v206, v213
    s_nop 0
    v_permlane32_swap_b32 v212, v199
    v_permlane32_swap_b32 v213, v206
    v_add_f32 v212, v212, v199
    v_add_f32 v213, v213, v206
    v_mul_f32 v212, 0x3b000000, v212
    v_mul_f32 v213, 0x3b000000, v213
    v_sub_f32 v197, 0, v212
    v_fma_f32 v213, v197, v212, v213
    v_max_f32 v213, 0, v213
    v_add_f32 v213, 0x3727c5ac, v213
    v_rsq_f32 v198, v213
    s_waitcnt vmcnt(12)
    s_waitcnt lgkmcnt(0)
    s_cmp_lg_u32 s3, 3
    s_cbranch_scc1 L_pskip_66
    s_mov_b64 s[94:95], exec
    s_mov_b64 exec, 1
    s_mov_b32 s91, 400000
    s_waitcnt vmcnt(9)
    s_branch L_pchk_69
L_ploop_67:
    buffer_load_dword v252, v250, s[72:75], 0 offen sc1
    s_waitcnt vmcnt(0)
L_pchk_69:
    v_cmp_ge_u32 vcc, v252, v251
    s_sub_u32 s91, s91, 1
    s_cbranch_scc1 L_pdone_68
    s_cmp_eq_u64 vcc, exec
    s_cbranch_scc0 L_ploop_67
L_pdone_68:
    s_mov_b64 exec, s[94:95]
L_pskip_66:
    s_barrier
    v_lshlrev_b32 v196, 2, v2
    v_add_u32 v196, 133120, v196
    ds_read_b32 v208, v196 offset:0
    ds_read_b32 v212, v196 offset:128
    ds_read_b32 v216, v196 offset:256
    ds_read_b32 v209, v196 offset:384
    ds_read_b32 v213, v196 offset:512
    ds_read_b32 v217, v196 offset:640
    ds_read_b32 v210, v196 offset:768
    ds_read_b32 v214, v196 offset:896
    ds_read_b32 v218, v196 offset:1024
    ds_read_b32 v211, v196 offset:1152
    ds_read_b32 v215, v196 offset:1280
    ds_read_b32 v219, v196 offset:1408
    v_cmp_gt_u32 vcc, 32, v1
    s_lshl_b32 s93, s20, 15
    s_lshl_b32 s86, s5, 14
    s_add_u32 s93, s93, s86
    s_add_u32 s93, s93, s19
    s_add_u32 s93, s93, 262144
    s_mov_b32 s35, s93
    s_add_u32 s36, s93, 16384
    s_lshl_b32 s86, s37, 11
    s_and_b32 s86, s86, 16383
    s_add_u32 s93, s93, s86
    v_mul_f32 v228, 0xc0135761, v198
    v_mul_f32 v226, v198, v198
    v_mul_f32 v226, v226, v198
    v_mul_f32 v226, 0xbdd2d3e8, v226
    v_rcp_f32 v230, v198
    v_mov_b32 v229, v228
    v_mov_b32 v227, v226
    v_mov_b32 v231, v230
    s_waitcnt lgkmcnt(0)
    v_add_f32 v208, v208, v209
    v_add_f32 v210, v210, v211
    v_add_f32 v208, v208, v210
    v_cndmask_b32 v238, 0, v208, vcc
    v_add_f32 v212, v212, v213
    v_add_f32 v214, v214, v215
    v_add_f32 v212, v212, v214
    v_cndmask_b32 v239, 0, v212, vcc
    v_add_f32 v216, v216, v217
    v_add_f32 v218, v218, v219
    v_add_f32 v216, v216, v218
    v_cndmask_b32 v240, 0, v216, vcc
    s_nop 1
    v_mfma_f32_32x32x2_f32 v[144:159], v238, v197, v[144:159]
    v_mfma_f32_32x32x2_f32 v[160:175], v239, v197, v[160:175]
    v_mfma_f32_32x32x2_f32 v[176:191], v240, v197, v[176:191]
    buffer_load_dwordx4 a[0:3], v4, s[72:75], s93 offen offset:0 sc1
    buffer_load_dwordx4 a[4:7], v4, s[72:75], s93 offen offset:1024 sc1
    buffer_load_dwordx4 a[8:11], v4, s[72:75], s93 offen offset:2048 sc1
    s_nop 13
    v_pk_mul_f32 v[232:233], v[144:145], v[144:145]
    v_pk_mul_f32 v[234:235], v[146:147], v[146:147]
    buffer_load_dwordx4 a[12:15], v4, s[72:75], s93 offen offset:3072 sc1
    v_pk_fma_f32 v[232:233], v[232:233], v[226:227], v[228:229]
    v_pk_fma_f32 v[234:235], v[234:235], v[226:227], v[228:229]
    v_pk_mul_f32 v[232:233], v[232:233], v[144:145]
    v_pk_mul_f32 v[234:235], v[234:235], v[146:147]
    v_exp_f32 v232, v232
    v_exp_f32 v233, v233
    v_exp_f32 v234, v234
    v_exp_f32 v235, v235
    v_pk_fma_f32 v[232:233], v[232:233], v[230:231], v[230:231]
    v_pk_fma_f32 v[234:235], v[234:235], v[230:231], v[230:231]
    v_rcp_f32 v232, v232
    s_add_u32 s93, s93, 4096
    buffer_load_dwordx4 a[16:19], v4, s[72:75], s93 offen offset:0 sc1
    v_rcp_f32 v233, v233
    v_rcp_f32 v234, v234
    v_rcp_f32 v235, v235
    v_pk_mul_f32 v[232:233], v[232:233], v[144:145]
    v_pk_mul_f32 v[234:235], v[234:235], v[146:147]
    v_cvt_pk_bf16_f32 v144, v232, v233
    v_cvt_pk_bf16_f32 v145, v234, v235
    v_pk_mul_f32 v[232:233], v[148:149], v[148:149]
    v_pk_mul_f32 v[234:235], v[150:151], v[150:151]
    v_pk_fma_f32 v[232:233], v[232:233], v[226:227], v[228:229]
    v_pk_fma_f32 v[234:235], v[234:235], v[226:227], v[228:229]
    v_pk_mul_f32 v[232:233], v[232:233], v[148:149]
    v_pk_mul_f32 v[234:235], v[234:235], v[150:151]
    buffer_load_dwordx4 a[20:23], v4, s[72:75], s93 offen offset:1024 sc1
    v_exp_f32 v232, v232
    v_exp_f32 v233, v233
    v_exp_f32 v234, v234
    v_exp_f32 v235, v235
    v_pk_fma_f32 v[232:233], v[232:233], v[230:231], v[230:231]
    v_pk_fma_f32 v[234:235], v[234:235], v[230:231], v[230:231]
    v_rcp_f32 v232, v232
    v_rcp_f32 v233, v233
    v_rcp_f32 v234, v234
    buffer_load_dwordx4 a[24:27], v4, s[72:75], s93 offen offset:2048 sc1
    v_rcp_f32 v235, v235
    v_pk_mul_f32 v[232:233], v[232:233], v[148:149]
    v_pk_mul_f32 v[234:235], v[234:235], v[150:151]
    v_cvt_pk_bf16_f32 v146, v232, v233
    v_cvt_pk_bf16_f32 v147, v234, v235
    v_pk_mul_f32 v[232:233], v[152:153], v[152:153]
    v_pk_mul_f32 v[234:235], v[154:155], v[154:155]
    v_pk_fma_f32 v[232:233], v[232:233], v[226:227], v[228:229]
    v_pk_fma_f32 v[234:235], v[234:235], v[226:227], v[228:229]
    v_pk_mul_f32 v[232:233], v[232:233], v[152:153]
    v_pk_mul_f32 v[234:235], v[234:235], v[154:155]
    v_exp_f32 v232, v232
    v_exp_f32 v233, v233
    buffer_load_dwordx4 a[28:31], v4, s[72:75], s93 offen offset:3072 sc1
    v_exp_f32 v234, v234
    v_exp_f32 v235, v235
    v_pk_fma_f32 v[232:233], v[232:233], v[230:231], v[230:231]
    v_pk_fma_f32 v[234:235], v[234:235], v[230:231], v[230:231]
    v_rcp_f32 v232, v232
    v_rcp_f32 v233, v233
    v_rcp_f32 v234, v234
    v_rcp_f32 v235, v235
    v_pk_mul_f32 v[232:233], v[232:233], v[152:153]
    v_pk_mul_f32 v[234:235], v[234:235], v[154:155]
    s_add_u32 s93, s93, 4096
    buffer_load_dwordx4 a[32:35], v4, s[72:75], s93 offen offset:0 sc1
    v_cvt_pk_bf16_f32 v148, v232, v233
    v_cvt_pk_bf16_f32 v149, v234, v235
    v_pk_mul_f32 v[232:233], v[156:157], v[156:157]
    v_pk_mul_f32 v[234:235], v[158:159], v[158:159]
    v_pk_fma_f32 v[232:233], v[232:233], v[226:227], v[228:229]
    v_pk_fma_f32 v[234:235], v[234:235], v[226:227], v[228:229]
    v_pk_mul_f32 v[232:233], v[232:233], v[156:157]
    v_pk_mul_f32 v[234:235], v[234:235], v[158:159]
    v_exp_f32 v232, v232
    v_exp_f32 v233, v233
    v_exp_f32 v234, v234
    v_exp_f32 v235, v235
    buffer_load_dwordx4 a[36:39], v4, s[72:75], s93 offen offset:1024 sc1
    v_pk_fma_f32 v[232:233], v[232:233], v[230:231], v[230:231]
    v_pk_fma_f32 v[234:235], v[234:235], v[230:231], v[230:231]
    v_rcp_f32 v232, v232
    v_rcp_f32 v233, v233
    v_rcp_f32 v234, v234
    v_rcp_f32 v235, v235
    v_pk_mul_f32 v[232:233], v[232:233], v[156:157]
    v_pk_mul_f32 v[234:235], v[234:235], v[158:159]
    v_cvt_pk_bf16_f32 v150, v232, v233
    v_cvt_pk_bf16_f32 v151, v234, v235
    buffer_store_dwordx4 v[144:147], v4, s[72:75], s18 offen offset:0 sc1
    buffer_store_dwordx4 v[148:151], v4, s[72:75], s18 offen offset:1024 sc1
    v_pk_mul_f32 v[232:233], v[160:161], v[160:161]
    v_pk_mul_f32 v[234:235], v[162:163], v[162:163]
    buffer_load_dwordx4 a[40:43], v4, s[72:75], s93 offen offset:2048 sc1
    v_pk_fma_f32 v[232:233], v[232:233], v[226:227], v[228:229]
    v_pk_fma_f32 v[234:235], v[234:235], v[226:227], v[228:229]
    v_pk_mul_f32 v[232:233], v[232:233], v[160:161]
    v_pk_mul_f32 v[234:235], v[234:235], v[162:163]
    v_exp_f32 v232, v232
    v_exp_f32 v233, v233
    v_exp_f32 v234, v234
    v_exp_f32 v235, v235
    v_pk_fma_f32 v[232:233], v[232:233], v[230:231], v[230:231]
    v_pk_fma_f32 v[234:235], v[234:235], v[230:231], v[230:231]
    v_rcp_f32 v232, v232
    buffer_load_dwordx4 a[44:47], v4, s[72:75], s93 offen offset:3072 sc1
    v_rcp_f32 v233, v233
    v_rcp_f32 v234, v234
    v_rcp_f32 v235, v235
    v_pk_mul_f32 v[232:233], v[232:233], v[160:161]
    v_pk_mul_f32 v[234:235], v[234:235], v[162:163]
    v_cvt_pk_bf16_f32 v160, v232, v233
    v_cvt_pk_bf16_f32 v161, v234, v235
    v_pk_mul_f32 v[232:233], v[164:165], v[164:165]
    v_pk_mul_f32 v[234:235], v[166:167], v[166:167]
    v_pk_fma_f32 v[232:233], v[232:233], v[226:227], v[228:229]
    v_pk_fma_f32 v[234:235], v[234:235], v[226:227], v[228:229]
    v_pk_mul_f32 v[232:233], v[232:233], v[164:165]
    v_pk_mul_f32 v[234:235], v[234:235], v[166:167]
    s_add_u32 s93, s93, 4096
    buffer_load_dwordx4 a[48:51], v4, s[72:75], s93 offen offset:0 sc1
    v_exp_f32 v232, v232
    v_exp_f32 v233, v233
    v_exp_f32 v234, v234
    v_exp_f32 v235, v235
    v_pk_fma_f32 v[232:233], v[232:233], v[230:231], v[230:231]
    v_pk_fma_f32 v[234:235], v[234:235], v[230:231], v[230:231]
    v_rcp_f32 v232, v232
    v_rcp_f32 v233, v233
    v_rcp_f32 v234, v234
    buffer_load_dwordx4 a[52:55], v4, s[72:75], s93 offen offset:1024 sc1
    v_rcp_f32 v235, v235
    v_pk_mul_f32 v[232:233], v[232:233], v[164:165]
    v_pk_mul_f32 v[234:235], v[234:235], v[166:167]
    v_cvt_pk_bf16_f32 v162, v232, v233
    v_cvt_pk_bf16_f32 v163, v234, v235
    v_pk_mul_f32 v[232:233], v[168:169], v[168:169]
    v_pk_mul_f32 v[234:235], v[170:171], v[170:171]
    v_pk_fma_f32 v[232:233], v[232:233], v[226:227], v[228:229]
    v_pk_fma_f32 v[234:235], v[234:235], v[226:227], v[228:229]
    v_pk_mul_f32 v[232:233], v[232:233], v[168:169]
    v_pk_mul_f32 v[234:235], v[234:235], v[170:171]
    v_exp_f32 v232, v232
    v_exp_f32 v233, v233
    buffer_load_dwordx4 a[56:59], v4, s[72:75], s93 offen offset:2048 sc1
    v_exp_f32 v234, v234
    v_exp_f32 v235, v235
    v_pk_fma_f32 v[232:233], v[232:233], v[230:231], v[230:231]
    v_pk_fma_f32 v[234:235], v[234:235], v[230:231], v[230:231]
    v_rcp_f32 v232, v232
    v_rcp_f32 v233, v233
    v_rcp_f32 v234, v234
    v_rcp_f32 v235, v235
    v_pk_mul_f32 v[232:233], v[232:233], v[168:169]
    v_pk_mul_f32 v[234:235], v[234:235], v[170:171]
    buffer_load_dwordx4 a[60:63], v4, s[72:75], s93 offen offset:3072 sc1
    v_cvt_pk_bf16_f32 v164, v232, v233
    v_cvt_pk_bf16_f32 v165, v234, v235
    v_pk_mul_f32 v[232:233], v[172:173], v[172:173]
    v_pk_mul_f32 v[234:235], v[174:175], v[174:175]
    v_pk_fma_f32 v[232:233], v[232:233], v[226:227], v[228:229]
    v_pk_fma_f32 v[234:235], v[234:235], v[226:227], v[228:229]
    v_pk_mul_f32 v[232:233], v[232:233], v[172:173]
    v_pk_mul_f32 v[234:235], v[234:235], v[174:175]
    v_exp_f32 v232, v232
    v_exp_f32 v233, v233
    v_exp_f32 v234, v234
    v_exp_f32 v235, v235
    s_add_u32 m0, s12, 0
    s_add_u32 s83, s34, 1146880
    buffer_load_dwordx4 v5, s[64:67], s83 offen lds
    v_pk_fma_f32 v[232:233], v[232:233], v[230:231], v[230:231]
    v_pk_fma_f32 v[234:235], v[234:235], v[230:231], v[230:231]
    v_rcp_f32 v232, v232
    v_rcp_f32 v233, v233
    v_rcp_f32 v234, v234
    v_rcp_f32 v235, v235
    v_pk_mul_f32 v[232:233], v[232:233], v[172:173]
    v_pk_mul_f32 v[234:235], v[234:235], v[174:175]
    v_cvt_pk_bf16_f32 v166, v232, v233
    v_cvt_pk_bf16_f32 v167, v234, v235
    buffer_store_dwordx4 v[160:163], v4, s[72:75], s18 offen offset:2048 sc1
    buffer_store_dwordx4 v[164:167], v4, s[72:75], s18 offen offset:3072 sc1
    s_cmp_lt_u32 s90, 3
    s_cbranch_scc1 L_nog2_70
    v_pk_mul_f32 v[232:233], v[176:177], v[176:177]
    v_pk_mul_f32 v[234:235], v[178:179], v[178:179]
    v_pk_fma_f32 v[232:233], v[232:233], v[226:227], v[228:229]
    v_pk_fma_f32 v[234:235], v[234:235], v[226:227], v[228:229]
    v_pk_mul_f32 v[232:233], v[232:233], v[176:177]
    v_pk_mul_f32 v[234:235], v[234:235], v[178:179]
    v_exp_f32 v232, v232
    v_exp_f32 v233, v233
    v_exp_f32 v234, v234
    v_exp_f32 v235, v235
    v_pk_fma_f32 v[232:233], v[232:233], v[230:231], v[230:231]
    v_pk_fma_f32 v[234:235], v[234:235], v[230:231], v[230:231]
    v_rcp_f32 v232, v232
    v_rcp_f32 v233, v233
    v_rcp_f32 v234, v234
    v_rcp_f32 v235, v235
    v_pk_mul_f32 v[232:233], v[232:233], v[176:177]
    v_pk_mul_f32 v[234:235], v[234:235], v[178:179]
    v_cvt_pk_bf16_f32 v176, v232, v233
    v_cvt_pk_bf16_f32 v177, v234, v235
    v_pk_mul_f32 v[232:233], v[180:181], v[180:181]
    v_pk_mul_f32 v[234:235], v[182:183], v[182:183]
    v_pk_fma_f32 v[232:233], v[232:233], v[226:227], v[228:229]
    v_pk_fma_f32 v[234:235], v[234:235], v[226:227], v[228:229]
    v_pk_mul_f32 v[232:233], v[232:233], v[180:181]
    v_pk_mul_f32 v[234:235], v[234:235], v[182:183]
    v_exp_f32 v232, v232
    v_exp_f32 v233, v233
    v_exp_f32 v234, v234
    v_exp_f32 v235, v235
    v_pk_fma_f32 v[232:233], v[232:233], v[230:231], v[230:231]
    v_pk_fma_f32 v[234:235], v[234:235], v[230:231], v[230:231]
    v_rcp_f32 v232, v232
    v_rcp_f32 v233, v233
    v_rcp_f32 v234, v234
    v_rcp_f32 v235, v235
    v_pk_mul_f32 v[232:233], v[232:233], v[180:181]
    v_pk_mul_f32 v[234:235], v[234:235], v[182:183]
    v_cvt_pk_bf16_f32 v178, v232, v233
    v_cvt_pk_bf16_f32 v179, v234, v235
    v_pk_mul_f32 v[232:233], v[184:185], v[184:185]
    v_pk_mul_f32 v[234:235], v[186:187], v[186:187]
    v_pk_fma_f32 v[232:233], v[232:233], v[226:227], v[228:229]
    v_pk_fma_f32 v[234:235], v[234:235], v[226:227], v[228:229]
    v_pk_mul_f32 v[232:233], v[232:233], v[184:185]
    v_pk_mul_f32 v[234:235], v[234:235], v[186:187]
    v_exp_f32 v232, v232
    v_exp_f32 v233, v233
    v_exp_f32 v234, v234
    v_exp_f32 v235, v235
    v_pk_fma_f32 v[232:233], v[232:233], v[230:231], v[230:231]
    v_pk_fma_f32 v[234:235], v[234:235], v[230:231], v[230:231]
    v_rcp_f32 v232, v232
    v_rcp_f32 v233, v233
    v_rcp_f32 v234, v234
    v_rcp_f32 v235, v235
    v_pk_mul_f32 v[232:233], v[232:233], v[184:185]
    v_pk_mul_f32 v[234:235], v[234:235], v[186:187]
    v_cvt_pk_bf16_f32 v180, v232, v233
    v_cvt_pk_bf16_f32 v181, v234, v235
    v_pk_mul_f32 v[232:233], v[188:189], v[188:189]
    v_pk_mul_f32 v[234:235], v[190:191], v[190:191]
    v_pk_fma_f32 v[232:233], v[232:233], v[226:227], v[228:229]
    v_pk_fma_f32 v[234:235], v[234:235], v[226:227], v[228:229]
    v_pk_mul_f32 v[232:233], v[232:233], v[188:189]
    v_pk_mul_f32 v[234:235], v[234:235], v[190:191]
    v_exp_f32 v232, v232
    v_exp_f32 v233, v233
    v_exp_f32 v234, v234
    v_exp_f32 v235, v235
    v_pk_fma_f32 v[232:233], v[232:233], v[230:231], v[230:231]
    v_pk_fma_f32 v[234:235], v[234:235], v[230:231], v[230:231]
    v_rcp_f32 v232, v232
    v_rcp_f32 v233, v233
    v_rcp_f32 v234, v234
    v_rcp_f32 v235, v235
    v_pk_mul_f32 v[232:233], v[232:233], v[188:189]
    v_pk_mul_f32 v[234:235], v[234:235], v[190:191]
    v_cvt_pk_bf16_f32 v182, v232, v233
    v_cvt_pk_bf16_f32 v183, v234, v235
    s_add_u32 s18, s18, 4096
    buffer_store_dwordx4 v[176:179], v4, s[72:75], s18 offen offset:0 sc1
    buffer_store_dwordx4 v[180:183], v4, s[72:75], s18 offen offset:1024 sc1
L_nog2_70:
    s_lshl_b32 s85, s5, 11
    v_add_u32 v246, s85, v11
    v_add_u32 v247, s85, v12
    v_add_u32 v244, 116736, v246
    v_add_u32 v245, 116736, v247
    ds_read_b64_tr_b16 v[96:97], v244 offset:0
    ds_read_b64_tr_b16 v[98:99], v244 offset:1024
    ds_read_b64_tr_b16 v[100:101], v245 offset:0
    ds_read_b64_tr_b16 v[102:103], v245 offset:1024
    ds_read_b64_tr_b16 v[104:105], v244 offset:4096
    ds_read_b64_tr_b16 v[106:107], v244 offset:5120
    ds_read_b64_tr_b16 v[108:109], v245 offset:4096
    ds_read_b64_tr_b16 v[110:111], v245 offset:5120
    ds_read_b64_tr_b16 v[112:113], v244 offset:8192
    ds_read_b64_tr_b16 v[114:115], v244 offset:9216
    ds_read_b64_tr_b16 v[116:117], v245 offset:8192
    ds_read_b64_tr_b16 v[118:119], v245 offset:9216
    ds_read_b64_tr_b16 v[120:121], v244 offset:12288
    ds_read_b64_tr_b16 v[122:123], v244 offset:13312
    ds_read_b64_tr_b16 v[124:125], v245 offset:12288
    ds_read_b64_tr_b16 v[126:127], v245 offset:13312
    s_mul_i32 s96, s20, 88064
    s_lshl_b32 s86, s5, 10
    s_add_u32 s96, s96, s86
    s_add_u32 s96, s96, s19
    s_add_u32 s35, s96, 786432
    s_waitcnt vmcnt(9)
    s_waitcnt lgkmcnt(0)
    s_barrier
    s_cmp_lg_u32 s3, 3
    s_cbranch_scc1 L_askip_71
    s_mov_b64 s[94:95], exec
    s_mov_b64 exec, 1
    s_and_b32 s97, s8, 1
    s_lshl_b32 s97, s97, 8
    s_add_u32 s97, s97, s19
    s_add_u32 s97, s97, 1708032
    v_mov_b32 v248, s97
    v_mov_b32 v249, 1
    buffer_atomic_add v249, v248, s[72:75], 0 offen
    s_mov_b64 exec, s[94:95]
L_askip_71:
    s_waitcnt vmcnt(20)
    v_mfma_f32_32x32x16_bf16 v[144:159], a[128:131], a[0:3], 0
    buffer_load_dwordx4 v136, s[64:67], s83 offen offset:1024 lds
    v_mfma_f32_32x32x16_bf16 v[160:175], a[132:135], a[0:3], 0
    s_waitcnt vmcnt(20)
    v_mfma_f32_32x32x16_bf16 v[144:159], a[136:139], a[4:7], v[144:159]
    buffer_load_dwordx4 v137, s[64:67], s83 offen offset:2048 lds
    v_mfma_f32_32x32x16_bf16 v[160:175], a[140:143], a[4:7], v[160:175]
    s_waitcnt vmcnt(20)
    v_mfma_f32_32x32x16_bf16 v[144:159], a[144:147], a[8:11], v[144:159]
    buffer_load_dwordx4 v138, s[64:67], s83 offen offset:3072 lds
    v_mfma_f32_32x32x16_bf16 v[160:175], a[148:151], a[8:11], v[160:175]
    s_waitcnt vmcnt(20)
    v_mfma_f32_32x32x16_bf16 v[144:159], a[152:155], a[12:15], v[144:159]
    s_add_u32 m0, s12, 16384
    s_add_u32 s83, s33, 32768
    buffer_load_dwordx4 v5, s[64:67], s83 offen lds
    v_mfma_f32_32x32x16_bf16 v[160:175], a[156:159], a[12:15], v[160:175]
    s_waitcnt vmcnt(20)
    v_mfma_f32_32x32x16_bf16 v[144:159], a[160:163], a[16:19], v[144:159]
    buffer_load_dwordx4 v136, s[64:67], s83 offen offset:1024 lds
    v_mfma_f32_32x32x16_bf16 v[160:175], a[164:167], a[16:19], v[160:175]
    s_waitcnt vmcnt(20)
    v_mfma_f32_32x32x16_bf16 v[144:159], a[168:171], a[20:23], v[144:159]
    buffer_load_dwordx4 v137, s[64:67], s83 offen offset:2048 lds
    v_mfma_f32_32x32x16_bf16 v[160:175], a[172:175], a[20:23], v[160:175]
    s_waitcnt vmcnt(20)
    v_mfma_f32_32x32x16_bf16 v[144:159], a[176:179], a[24:27], v[144:159]
    buffer_load_dwordx4 v138, s[64:67], s83 offen offset:3072 lds
    v_mfma_f32_32x32x16_bf16 v[160:175], a[180:183], a[24:27], v[160:175]
    s_waitcnt vmcnt(20)
    v_mfma_f32_32x32x16_bf16 v[144:159], a[184:187], a[28:31], v[144:159]
    s_add_u32 m0, s12, 32768
    s_add_u32 s83, s33, 425984
    buffer_load_dwordx4 v5, s[64:67], s83 offen lds
    v_mfma_f32_32x32x16_bf16 v[160:175], a[188:191], a[28:31], v[160:175]
    s_waitcnt vmcnt(20)
    v_mfma_f32_32x32x16_bf16 v[144:159], a[192:195], a[32:35], v[144:159]
    buffer_load_dwordx4 v136, s[64:67], s83 offen offset:1024 lds
    v_mfma_f32_32x32x16_bf16 v[160:175], a[196:199], a[32:35], v[160:175]
    s_waitcnt vmcnt(20)
    v_mfma_f32_32x32x16_bf16 v[144:159], a[200:203], a[36:39], v[144:159]
    buffer_load_dwordx4 v137, s[64:67], s83 offen offset:2048 lds
    v_mfma_f32_32x32x16_bf16 v[160:175], a[204:207], a[36:39], v[160:175]
    s_waitcnt vmcnt(18)
    v_mfma_f32_32x32x16_bf16 v[144:159], a[208:211], a[40:43], v[144:159]
    buffer_load_dwordx4 v138, s[64:67], s83 offen offset:3072 lds
    v_mfma_f32_32x32x16_bf16 v[160:175], a[212:215], a[40:43], v[160:175]
    s_waitcnt vmcnt(18)
    v_mfma_f32_32x32x16_bf16 v[144:159], a[216:219], a[44:47], v[144:159]
    s_add_u32 m0, s12, 49152
    s_add_u32 s83, s33, 819200
    buffer_load_dwordx4 v5, s[64:67], s83 offen lds
    v_mfma_f32_32x32x16_bf16 v[160:175], a[220:223], a[44:47], v[160:175]
    s_waitcnt vmcnt(18)
    v_mfma_f32_32x32x16_bf16 v[144:159], a[224:227], a[48:51], v[144:159]
    buffer_load_dwordx4 v136, s[64:67], s83 offen offset:1024 lds
    v_mfma_f32_32x32x16_bf16 v[160:175], a[228:231], a[48:51], v[160:175]
    s_waitcnt vmcnt(13)
    s_barrier
    s_cmp_lg_u32 s3, 3
    s_cbranch_scc1 L_askip_72
    s_mov_b64 s[94:95], exec
    s_mov_b64 exec, 1
    s_and_b32 s97, s8, 1
    s_lshl_b32 s97, s97, 8
    s_add_u32 s97, s97, s19
    s_add_u32 s97, s97, 1708544
    v_mov_b32 v248, s97
    v_mov_b32 v249, 1
    buffer_atomic_add v249, v248, s[72:75], 0 offen
    s_mov_b64 exec, s[94:95]
L_askip_72:
    s_waitcnt vmcnt(18)
    v_mfma_f32_32x32x16_bf16 v[144:159], a[232:235], a[52:55], v[144:159]
    buffer_load_dwordx4 v137, s[64:67], s83 offen offset:2048 lds
    v_mfma_f32_32x32x16_bf16 v[160:175], a[236:239], a[52:55], v[160:175]
    s_cmp_lg_u32 s3, 3
    s_cbranch_scc1 L_piskip_73
    s_and_b32 s97, s8, 1
    s_lshl_b32 s97, s97, 8
    s_add_u32 s97, s97, s19
    s_add_u32 s97, s97, 1708032
    v_mov_b32 v250, s97
    v_mov_b32 v251, 16
    s_mov_b64 s[94:95], exec
    s_mov_b64 exec, 1
    buffer_load_dword v252, v250, s[72:75], 0 offen sc1
    s_mov_b64 exec, s[94:95]
L_piskip_73:
    s_waitcnt vmcnt(18)
    v_mfma_f32_32x32x16_bf16 v[144:159], a[240:243], a[56:59], v[144:159]
    buffer_load_dwordx4 v138, s[64:67], s83 offen offset:3072 lds
    v_mfma_f32_32x32x16_bf16 v[160:175], a[244:247], a[56:59], v[160:175]
    s_waitcnt vmcnt(18)
    v_mfma_f32_32x32x16_bf16 v[144:159], a[248:251], a[60:63], v[144:159]
    s_add_u32 m0, s12, 133120
    s_add_u32 s83, s34, 1179648
    buffer_load_dwordx4 v5, s[64:67], s83 offen lds
    v_mfma_f32_32x32x16_bf16 v[160:175], a[252:255], a[60:63], v[160:175]
    s_waitcnt vmcnt(16)
    s_barrier
    s_cmp_lg_u32 s3, 3
    s_cbranch_scc1 L_askip_74
    s_mov_b64 s[94:95], exec
    s_mov_b64 exec, 1
    s_and_b32 s97, s8, 1
    s_lshl_b32 s97, s97, 8
    s_add_u32 s97, s97, s19
    s_add_u32 s97, s97, 1709056
    v_mov_b32 v248, s97
    v_mov_b32 v249, 1
    buffer_atomic_add v249, v248, s[72:75], 0 offen
    s_mov_b64 exec, s[94:95]
L_askip_74:
    v_add_u32 v236, 0, v246
    v_add_u32 v237, 0, v247
    v_add_u32 v238, 65536, v246
    v_add_u32 v239, 65536, v247
    v_add_u32 v240, 131072, v246
    v_add_u32 v241, 131072, v247
    buffer_load_dwordx4 v136, s[64:67], s83 offen offset:1024 lds
    buffer_load_dwordx4 v137, s[64:67], s83 offen offset:2048 lds
    buffer_load_dwordx4 v138, s[64:67], s83 offen offset:3072 lds
    s_mov_b32 s39, 65536
    s_mov_b32 s92, 149504
    s_cmp_ge_u32 s3, 1
    s_cselect_b32 s39, 163840, s39
    s_cselect_b32 s92, 153600, s92
    s_cmp_ge_u32 s3, 2
    s_cselect_b32 s39, 262144, s39
    s_cselect_b32 s92, 157696, s92
    s_cmp_ge_u32 s3, 3
    s_cselect_b32 s39, 262144, s39
    s_cselect_b32 s92, 157696, s92
    s_mov_b32 m0, s92
    s_lshl_b32 s83, s7, 7
    s_add_u32 s83, s83, s39
    buffer_load_dwordx4 v5, s[64:67], s83 offen lds
    buffer_load_dwordx4 v136, s[64:67], s83 offen offset:1024 lds
    buffer_load_dwordx4 v137, s[64:67], s83 offen offset:2048 lds
    buffer_load_dwordx4 v138, s[64:67], s83 offen offset:3072 lds
    s_add_u32 m0, s12, 116736
    s_add_u32 s83, s33, 360448
    buffer_load_dwordx4 v5, s[64:67], s83 offen lds
    buffer_load_dwordx4 v136, s[64:67], s83 offen offset:1024 lds
    buffer_load_dwordx4 v137, s[64:67], s83 offen offset:2048 lds
    buffer_load_dwordx4 v138, s[64:67], s83 offen offset:3072 lds
    s_waitcnt vmcnt(48)
    s_cmp_lg_u32 s3, 3
    s_cbranch_scc1 L_pskip_75
    s_mov_b64 s[94:95], exec
    s_mov_b64 exec, 1
    s_mov_b32 s91, 400000
    s_waitcnt vmcnt(13)
    s_branch L_pchk_78
L_ploop_76:
    buffer_load_dword v252, v250, s[72:75], 0 offen sc1
    s_waitcnt vmcnt(0)
L_pchk_78:
    v_cmp_ge_u32 vcc, v252, v251
    s_sub_u32 s91, s91, 1
    s_cbranch_scc1 L_pdone_77
    s_cmp_eq_u64 vcc, exec
    s_cbranch_scc0 L_ploop_76
L_pdone_77:
    s_mov_b64 exec, s[94:95]
L_pskip_75:
    s_barrier
    s_cmp_lg_u32 s3, 3
    s_cbranch_scc1 L_piskip_79
    s_and_b32 s97, s8, 1
    s_lshl_b32 s97, s97, 8
    s_add_u32 s97, s97, s19
    s_add_u32 s97, s97, 1708544
    v_mov_b32 v250, s97
    v_mov_b32 v251, 16
    s_mov_b64 s[94:95], exec
    s_mov_b64 exec, 1
    buffer_load_dword v252, v250, s[72:75], 0 offen sc1
    s_mov_b64 exec, s[94:95]
L_piskip_79:
    s_add_u32 s96, s35, 0
    buffer_load_dwordx4 a[64:67], v4, s[72:75], s96 offen sc1
    s_add_u32 s96, s35, 6144
    buffer_load_dwordx4 a[68:71], v4, s[72:75], s96 offen sc1
    s_add_u32 s96, s35, 12288
    buffer_load_dwordx4 a[72:75], v4, s[72:75], s96 offen sc1
    s_add_u32 s96, s35, 18432
    buffer_load_dwordx4 a[76:79], v4, s[72:75], s96 offen sc1
    s_add_u32 s96, s35, 24576
    buffer_load_dwordx4 a[80:83], v4, s[72:75], s96 offen sc1
    s_add_u32 s96, s35, 30720
    buffer_load_dwordx4 a[84:87], v4, s[72:75], s96 offen sc1
    s_add_u32 s96, s35, 36864
    buffer_load_dwordx4 a[88:91], v4, s[72:75], s96 offen sc1
    s_add_u32 s96, s35, 43008
    buffer_load_dwordx4 a[92:95], v4, s[72:75], s96 offen sc1
    s_add_u32 s96, s35, 49152
    buffer_load_dwordx4 a[96:99], v4, s[72:75], s96 offen sc1
    s_add_u32 s96, s35, 55296
    buffer_load_dwordx4 a[100:103], v4, s[72:75], s96 offen sc1
    ds_read_b64_tr_b16 v[64:65], v238 offset:2048
    ds_read_b64_tr_b16 v[66:67], v238 offset:3072
    ds_read_b64_tr_b16 v[68:69], v239 offset:2048
    ds_read_b64_tr_b16 v[70:71], v239 offset:3072
    ds_read_b64_tr_b16 v[72:73], v238 offset:6144
    ds_read_b64_tr_b16 v[74:75], v238 offset:7168
    ds_read_b64_tr_b16 v[76:77], v239 offset:6144
    ds_read_b64_tr_b16 v[78:79], v239 offset:7168
    s_waitcnt vmcnt(9) lgkmcnt(4)
    v_mfma_f32_32x32x16_bf16 v[144:159], v[64:67], a[64:67], v[144:159]
    ds_read_b64_tr_b16 v[80:81], v238 offset:10240
    ds_read_b64_tr_b16 v[82:83], v238 offset:11264
    v_mfma_f32_32x32x16_bf16 v[160:175], v[68:71], a[64:67], v[160:175]
    ds_read_b64_tr_b16 v[84:85], v239 offset:10240
    ds_read_b64_tr_b16 v[86:87], v239 offset:11264
    s_add_u32 s96, s35, 61440
    buffer_load_dwordx4 a[104:107], v4, s[72:75], s96 offen sc1
    s_waitcnt vmcnt(9) lgkmcnt(4)
    v_mfma_f32_32x32x16_bf16 v[144:159], v[72:75], a[68:71], v[144:159]
    ds_read_b64_tr_b16 v[88:89], v238 offset:14336
    ds_read_b64_tr_b16 v[90:91], v238 offset:15360
    v_mfma_f32_32x32x16_bf16 v[160:175], v[76:79], a[68:71], v[160:175]
    ds_read_b64_tr_b16 v[92:93], v239 offset:14336
    ds_read_b64_tr_b16 v[94:95], v239 offset:15360
    s_add_u32 s96, s35, 67584
    buffer_load_dwordx4 a[108:111], v4, s[72:75], s96 offen sc1
    s_waitcnt vmcnt(9) lgkmcnt(4)
    v_mfma_f32_32x32x16_bf16 v[144:159], v[80:83], a[72:75], v[144:159]
    ds_read_b64_tr_b16 v[64:65], v238 offset:18432
    ds_read_b64_tr_b16 v[66:67], v238 offset:19456
    v_mfma_f32_32x32x16_bf16 v[160:175], v[84:87], a[72:75], v[160:175]
    ds_read_b64_tr_b16 v[68:69], v239 offset:18432
    ds_read_b64_tr_b16 v[70:71], v239 offset:19456
    s_add_u32 s96, s35, 71680
    buffer_load_dwordx4 a[112:115], v4, s[72:75], s96 offen sc1
    s_waitcnt vmcnt(9) lgkmcnt(4)
    v_mfma_f32_32x32x16_bf16 v[144:159], v[88:91], a[76:79], v[144:159]
    ds_read_b64_tr_b16 v[72:73], v238 offset:22528
    ds_read_b64_tr_b16 v[74:75], v238 offset:23552
    v_mfma_f32_32x32x16_bf16 v[160:175], v[92:95], a[76:79], v[160:175]
    ds_read_b64_tr_b16 v[76:77], v239 offset:22528
    ds_read_b64_tr_b16 v[78:79], v239 offset:23552
    s_add_u32 s96, s35, 75776
    buffer_load_dwordx4 a[116:119], v4, s[72:75], s96 offen sc1
    s_waitcnt vmcnt(9) lgkmcnt(4)
    v_mfma_f32_32x32x16_bf16 v[144:159], v[64:67], a[80:83], v[144:159]
    ds_read_b64_tr_b16 v[80:81], v238 offset:26624
    ds_read_b64_tr_b16 v[82:83], v238 offset:27648
    v_mfma_f32_32x32x16_bf16 v[160:175], v[68:71], a[80:83], v[160:175]
    ds_read_b64_tr_b16 v[84:85], v239 offset:26624
    ds_read_b64_tr_b16 v[86:87], v239 offset:27648
    s_add_u32 s96, s35, 79872
    buffer_load_dwordx4 a[120:123], v4, s[72:75], s96 offen sc1
    s_waitcnt vmcnt(9) lgkmcnt(4)
    v_mfma_f32_32x32x16_bf16 v[144:159], v[72:75], a[84:87], v[144:159]
    ds_read_b64_tr_b16 v[88:89], v238 offset:30720
    ds_read_b64_tr_b16 v[90:91], v238 offset:31744
    v_mfma_f32_32x32x16_bf16 v[160:175], v[76:79], a[84:87], v[160:175]
    ds_read_b64_tr_b16 v[92:93], v239 offset:30720
    ds_read_b64_tr_b16 v[94:95], v239 offset:31744
    s_add_u32 s96, s35, 83968
    buffer_load_dwordx4 a[124:127], v4, s[72:75], s96 offen sc1
    s_waitcnt vmcnt(9) lgkmcnt(4)
    v_mfma_f32_32x32x16_bf16 v[144:159], v[80:83], a[88:91], v[144:159]
    ds_read_b64_tr_b16 v[64:65], v238 offset:34816
    ds_read_b64_tr_b16 v[66:67], v238 offset:35840
    v_mfma_f32_32x32x16_bf16 v[160:175], v[84:87], a[88:91], v[160:175]
    ds_read_b64_tr_b16 v[68:69], v239 offset:34816
    ds_read_b64_tr_b16 v[70:71], v239 offset:35840
    s_cmp_lg_u32 s3, 3
    s_cbranch_scc1 L_pskip_80
    s_mov_b64 s[94:95], exec
    s_mov_b64 exec, 1
    s_mov_b32 s91, 400000
    s_waitcnt vmcnt(16)
    s_branch L_pchk_83
L_ploop_81:
    buffer_load_dword v252, v250, s[72:75], 0 offen sc1
    s_waitcnt vmcnt(0)
L_pchk_83:
    v_cmp_ge_u32 vcc, v252, v251
    s_sub_u32 s91, s91, 1
    s_cbranch_scc1 L_pdone_82
    s_cmp_eq_u64 vcc, exec
    s_cbranch_scc0 L_ploop_81
L_pdone_82:
    s_mov_b64 exec, s[94:95]
L_pskip_80:
    s_barrier
    s_cmp_lg_u32 s3, 3
    s_cbranch_scc1 L_piskip_84
    s_and_b32 s97, s8, 1
    s_lshl_b32 s97, s97, 8
    s_add_u32 s97, s97, s19
    s_add_u32 s97, s97, 1709056
    v_mov_b32 v250, s97
    v_mov_b32 v251, 16
    s_mov_b64 s[94:95], exec
    s_mov_b64 exec, 1
    buffer_load_dword v252, v250, s[72:75], 0 offen sc1
    s_mov_b64 exec, s[94:95]
L_piskip_84:
    s_add_u32 s96, s35, 2048
    buffer_load_dwordx4 a[0:3], v4, s[72:75], s96 offen sc1
    s_waitcnt vmcnt(9) lgkmcnt(4)
    v_mfma_f32_32x32x16_bf16 v[144:159], v[88:91], a[92:95], v[144:159]
    ds_read_b64_tr_b16 v[72:73], v238 offset:38912
    ds_read_b64_tr_b16 v[74:75], v238 offset:39936
    v_mfma_f32_32x32x16_bf16 v[160:175], v[92:95], a[92:95], v[160:175]
    ds_read_b64_tr_b16 v[76:77], v239 offset:38912
    ds_read_b64_tr_b16 v[78:79], v239 offset:39936
    s_add_u32 s96, s35, 8192
    buffer_load_dwordx4 a[4:7], v4, s[72:75], s96 offen sc1
    s_waitcnt vmcnt(9) lgkmcnt(4)
    v_mfma_f32_32x32x16_bf16 v[144:159], v[64:67], a[96:99], v[144:159]
    ds_read_b64_tr_b16 v[80:81], v238 offset:43008
    ds_read_b64_tr_b16 v[82:83], v238 offset:44032
    v_mfma_f32_32x32x16_bf16 v[160:175], v[68:71], a[96:99], v[160:175]
    ds_read_b64_tr_b16 v[84:85], v239 offset:43008
    ds_read_b64_tr_b16 v[86:87], v239 offset:44032
    s_add_u32 s96, s35, 14336
    buffer_load_dwordx4 a[8:11], v4, s[72:75], s96 offen sc1
    s_waitcnt vmcnt(9) lgkmcnt(4)
    v_mfma_f32_32x32x16_bf16 v[144:159], v[72:75], a[100:103], v[144:159]
    ds_read_b64_tr_b16 v[88:89], v238 offset:47104
    ds_read_b64_tr_b16 v[90:91], v238 offset:48128
    v_mfma_f32_32x32x16_bf16 v[160:175], v[76:79], a[100:103], v[160:175]
    ds_read_b64_tr_b16 v[92:93], v239 offset:47104
    ds_read_b64_tr_b16 v[94:95], v239 offset:48128
    s_add_u32 s96, s35, 20480
    buffer_load_dwordx4 a[12:15], v4, s[72:75], s96 offen sc1
    s_waitcnt vmcnt(9) lgkmcnt(4)
    v_mfma_f32_32x32x16_bf16 v[144:159], v[80:83], a[104:107], v[144:159]
    ds_read_b64_tr_b16 v[64:65], v236 offset:0
    ds_read_b64_tr_b16 v[66:67], v236 offset:1024
    v_mfma_f32_32x32x16_bf16 v[160:175], v[84:87], a[104:107], v[160:175]
    ds_read_b64_tr_b16 v[68:69], v237 offset:0
    ds_read_b64_tr_b16 v[70:71], v237 offset:1024
    s_add_u32 s96, s35, 26624
    buffer_load_dwordx4 a[16:19], v4, s[72:75], s96 offen sc1
    s_waitcnt vmcnt(9) lgkmcnt(4)
    v_mfma_f32_32x32x16_bf16 v[144:159], v[88:91], a[108:111], v[144:159]
    ds_read_b64_tr_b16 v[72:73], v236 offset:4096
    ds_read_b64_tr_b16 v[74:75], v236 offset:5120
    v_mfma_f32_32x32x16_bf16 v[160:175], v[92:95], a[108:111], v[160:175]
    ds_read_b64_tr_b16 v[76:77], v237 offset:4096
    ds_read_b64_tr_b16 v[78:79], v237 offset:5120
    s_add_u32 s96, s35, 32768
    buffer_load_dwordx4 a[20:23], v4, s[72:75], s96 offen sc1
    s_waitcnt vmcnt(9) lgkmcnt(4)
    v_mfma_f32_32x32x16_bf16 v[144:159], v[64:67], a[112:115], v[144:159]
    ds_read_b64_tr_b16 v[80:81], v236 offset:8192
    ds_read_b64_tr_b16 v[82:83], v236 offset:9216
    v_mfma_f32_32x32x16_bf16 v[160:175], v[68:71], a[112:115], v[160:175]
    ds_read_b64_tr_b16 v[84:85], v237 offset:8192
    ds_read_b64_tr_b16 v[86:87], v237 offset:9216
    s_add_u32 s96, s35, 38912
    buffer_load_dwordx4 a[24:27], v4, s[72:75], s96 offen sc1
    s_waitcnt vmcnt(9) lgkmcnt(4)
    v_mfma_f32_32x32x16_bf16 v[144:159], v[72:75], a[116:119], v[144:159]
    ds_read_b64_tr_b16 v[88:89], v236 offset:12288
    ds_read_b64_tr_b16 v[90:91], v236 offset:13312
    v_mfma_f32_32x32x16_bf16 v[160:175], v[76:79], a[116:119], v[160:175]
    ds_read_b64_tr_b16 v[92:93], v237 offset:12288
    ds_read_b64_tr_b16 v[94:95], v237 offset:13312
    s_add_u32 s96, s35, 45056
    buffer_load_dwordx4 a[28:31], v4, s[72:75], s96 offen sc1
    s_waitcnt vmcnt(9) lgkmcnt(4)
    v_mfma_f32_32x32x16_bf16 v[144:159], v[80:83], a[120:123], v[144:159]
    ds_read_b64_tr_b16 v[64:65], v236 offset:16384
    ds_read_b64_tr_b16 v[66:67], v236 offset:17408
    v_mfma_f32_32x32x16_bf16 v[160:175], v[84:87], a[120:123], v[160:175]
    ds_read_b64_tr_b16 v[68:69], v237 offset:16384
    ds_read_b64_tr_b16 v[70:71], v237 offset:17408
    s_add_u32 s96, s35, 51200
    buffer_load_dwordx4 a[32:35], v4, s[72:75], s96 offen sc1
    s_waitcnt vmcnt(9) lgkmcnt(4)
    v_mfma_f32_32x32x16_bf16 v[144:159], v[88:91], a[124:127], v[144:159]
    ds_read_b64_tr_b16 v[72:73], v236 offset:20480
    ds_read_b64_tr_b16 v[74:75], v236 offset:21504
    v_mfma_f32_32x32x16_bf16 v[160:175], v[92:95], a[124:127], v[160:175]
    ds_read_b64_tr_b16 v[76:77], v237 offset:20480
    ds_read_b64_tr_b16 v[78:79], v237 offset:21504
    s_add_u32 s96, s35, 57344
    buffer_load_dwordx4 a[36:39], v4, s[72:75], s96 offen sc1
    s_waitcnt vmcnt(9) lgkmcnt(4)
    v_mfma_f32_32x32x16_bf16 v[144:159], v[64:67], a[0:3], v[144:159]
    ds_read_b64_tr_b16 v[80:81], v236 offset:24576
    ds_read_b64_tr_b16 v[82:83], v236 offset:25600
    v_mfma_f32_32x32x16_bf16 v[160:175], v[68:71], a[0:3], v[160:175]
    ds_read_b64_tr_b16 v[84:85], v237 offset:24576
    ds_read_b64_tr_b16 v[86:87], v237 offset:25600
    s_add_u32 s96, s35, 63488
    buffer_load_dwordx4 a[40:43], v4, s[72:75], s96 offen sc1
    s_waitcnt vmcnt(9) lgkmcnt(4)
    v_mfma_f32_32x32x16_bf16 v[144:159], v[72:75], a[4:7], v[144:159]
    ds_read_b64_tr_b16 v[88:89], v236 offset:28672
    ds_read_b64_tr_b16 v[90:91], v236 offset:29696
    v_mfma_f32_32x32x16_bf16 v[160:175], v[76:79], a[4:7], v[160:175]
    ds_read_b64_tr_b16 v[92:93], v237 offset:28672
    ds_read_b64_tr_b16 v[94:95], v237 offset:29696
    s_add_u32 s96, s35, 69632
    buffer_load_dwordx4 a[44:47], v4, s[72:75], s96 offen sc1
    s_waitcnt vmcnt(9) lgkmcnt(4)
    v_mfma_f32_32x32x16_bf16 v[144:159], v[80:83], a[8:11], v[144:159]
    ds_read_b64_tr_b16 v[64:65], v236 offset:32768
    ds_read_b64_tr_b16 v[66:67], v236 offset:33792
    v_mfma_f32_32x32x16_bf16 v[160:175], v[84:87], a[8:11], v[160:175]
    ds_read_b64_tr_b16 v[68:69], v237 offset:32768
    ds_read_b64_tr_b16 v[70:71], v237 offset:33792
    s_add_u32 s96, s35, 73728
    buffer_load_dwordx4 a[48:51], v4, s[72:75], s96 offen sc1
    s_waitcnt vmcnt(9) lgkmcnt(4)
    v_mfma_f32_32x32x16_bf16 v[144:159], v[88:91], a[12:15], v[144:159]
    ds_read_b64_tr_b16 v[72:73], v236 offset:36864
    ds_read_b64_tr_b16 v[74:75], v236 offset:37888
    v_mfma_f32_32x32x16_bf16 v[160:175], v[92:95], a[12:15], v[160:175]
    ds_read_b64_tr_b16 v[76:77], v237 offset:36864
    ds_read_b64_tr_b16 v[78:79], v237 offset:37888
    s_add_u32 s96, s35, 77824
    buffer_load_dwordx4 a[52:55], v4, s[72:75], s96 offen sc1
    s_waitcnt vmcnt(9) lgkmcnt(4)
    v_mfma_f32_32x32x16_bf16 v[144:159], v[64:67], a[16:19], v[144:159]
    ds_read_b64_tr_b16 v[80:81], v236 offset:40960
    ds_read_b64_tr_b16 v[82:83], v236 offset:41984
    v_mfma_f32_32x32x16_bf16 v[160:175], v[68:71], a[16:19], v[160:175]
    ds_read_b64_tr_b16 v[84:85], v237 offset:40960
    ds_read_b64_tr_b16 v[86:87], v237 offset:41984
    s_add_u32 s96, s35, 81920
    buffer_load_dwordx4 a[56:59], v4, s[72:75], s96 offen sc1
    s_waitcnt vmcnt(9) lgkmcnt(4)
    v_mfma_f32_32x32x16_bf16 v[144:159], v[72:75], a[20:23], v[144:159]
    ds_read_b64_tr_b16 v[88:89], v236 offset:45056
    ds_read_b64_tr_b16 v[90:91], v236 offset:46080
    v_mfma_f32_32x32x16_bf16 v[160:175], v[76:79], a[20:23], v[160:175]
    ds_read_b64_tr_b16 v[92:93], v237 offset:45056
    ds_read_b64_tr_b16 v[94:95], v237 offset:46080
    s_add_u32 s96, s35, 86016
    buffer_load_dwordx4 a[60:63], v4, s[72:75], s96 offen sc1
    s_waitcnt vmcnt(9) lgkmcnt(4)
    v_mfma_f32_32x32x16_bf16 v[144:159], v[80:83], a[24:27], v[144:159]
    ds_read_b64_tr_b16 v[64:65], v236 offset:49152
    ds_read_b64_tr_b16 v[66:67], v236 offset:50176
    v_mfma_f32_32x32x16_bf16 v[160:175], v[84:87], a[24:27], v[160:175]
    ds_read_b64_tr_b16 v[68:69], v237 offset:49152
    ds_read_b64_tr_b16 v[70:71], v237 offset:50176
    s_cmp_lg_u32 s3, 3
    s_cbranch_scc1 L_pskip_85
    s_mov_b64 s[94:95], exec
    s_mov_b64 exec, 1
    s_mov_b32 s91, 400000
    s_waitcnt vmcnt(16)
    s_branch L_pchk_88
L_ploop_86:
    buffer_load_dword v252, v250, s[72:75], 0 offen sc1
    s_waitcnt vmcnt(0)
L_pchk_88:
    v_cmp_ge_u32 vcc, v252, v251
    s_sub_u32 s91, s91, 1
    s_cbranch_scc1 L_pdone_87
    s_cmp_eq_u64 vcc, exec
    s_cbranch_scc0 L_ploop_86
L_pdone_87:
    s_mov_b64 exec, s[94:95]
L_pskip_85:
    s_barrier
    s_add_u32 s96, s35, 4096
    buffer_load_dwordx4 a[64:67], v4, s[72:75], s96 offen sc1
    s_waitcnt vmcnt(9) lgkmcnt(4)
    v_mfma_f32_32x32x16_bf16 v[144:159], v[88:91], a[28:31], v[144:159]
    ds_read_b64_tr_b16 v[72:73], v236 offset:53248
    ds_read_b64_tr_b16 v[74:75], v236 offset:54272
    v_mfma_f32_32x32x16_bf16 v[160:175], v[92:95], a[28:31], v[160:175]
    ds_read_b64_tr_b16 v[76:77], v237 offset:53248
    ds_read_b64_tr_b16 v[78:79], v237 offset:54272
    s_add_u32 s96, s35, 10240
    buffer_load_dwordx4 a[68:71], v4, s[72:75], s96 offen sc1
    s_waitcnt vmcnt(9) lgkmcnt(4)
    v_mfma_f32_32x32x16_bf16 v[144:159], v[64:67], a[32:35], v[144:159]
    ds_read_b64_tr_b16 v[80:81], v236 offset:57344
    ds_read_b64_tr_b16 v[82:83], v236 offset:58368
    v_mfma_f32_32x32x16_bf16 v[160:175], v[68:71], a[32:35], v[160:175]
    ds_read_b64_tr_b16 v[84:85], v237 offset:57344
    ds_read_b64_tr_b16 v[86:87], v237 offset:58368
    s_add_u32 s96, s35, 16384
    buffer_load_dwordx4 a[72:75], v4, s[72:75], s96 offen sc1
    s_waitcnt vmcnt(9) lgkmcnt(4)
    v_mfma_f32_32x32x16_bf16 v[144:159], v[72:75], a[36:39], v[144:159]
    ds_read_b64_tr_b16 v[88:89], v236 offset:61440
    ds_read_b64_tr_b16 v[90:91], v236 offset:62464
    v_mfma_f32_32x32x16_bf16 v[160:175], v[76:79], a[36:39], v[160:175]
    ds_read_b64_tr_b16 v[92:93], v237 offset:61440
    ds_read_b64_tr_b16 v[94:95], v237 offset:62464
    s_add_u32 s96, s35, 22528
    buffer_load_dwordx4 a[76:79], v4, s[72:75], s96 offen sc1
    s_waitcnt vmcnt(9) lgkmcnt(4)
    v_mfma_f32_32x32x16_bf16 v[144:159], v[80:83], a[40:43], v[144:159]
    ds_read_b64_tr_b16 v[64:65], v240 offset:2048
    ds_read_b64_tr_b16 v[66:67], v240 offset:3072
    v_mfma_f32_32x32x16_bf16 v[160:175], v[84:87], a[40:43], v[160:175]
    ds_read_b64_tr_b16 v[68:69], v241 offset:2048
    ds_read_b64_tr_b16 v[70:71], v241 offset:3072
    s_add_u32 s96, s35, 28672
    buffer_load_dwordx4 a[80:83], v4, s[72:75], s96 offen sc1
    s_waitcnt vmcnt(9) lgkmcnt(4)
    v_mfma_f32_32x32x16_bf16 v[144:159], v[88:91], a[44:47], v[144:159]
    ds_read_b64_tr_b16 v[72:73], v240 offset:6144
    ds_read_b64_tr_b16 v[74:75], v240 offset:7168
    v_mfma_f32_32x32x16_bf16 v[160:175], v[92:95], a[44:47], v[160:175]
    ds_read_b64_tr_b16 v[76:77], v241 offset:6144
    ds_read_b64_tr_b16 v[78:79], v241 offset:7168
    s_add_u32 s96, s35, 34816
    buffer_load_dwordx4 a[84:87], v4, s[72:75], s96 offen sc1
    s_waitcnt vmcnt(9) lgkmcnt(4)
    v_mfma_f32_32x32x16_bf16 v[144:159], v[64:67], a[48:51], v[144:159]
    ds_read_b64_tr_b16 v[80:81], v240 offset:10240
    ds_read_b64_tr_b16 v[82:83], v240 offset:11264
    v_mfma_f32_32x32x16_bf16 v[160:175], v[68:71], a[48:51], v[160:175]
    ds_read_b64_tr_b16 v[84:85], v241 offset:10240
    ds_read_b64_tr_b16 v[86:87], v241 offset:11264
    s_add_u32 s96, s35, 40960
    buffer_load_dwordx4 a[88:91], v4, s[72:75], s96 offen sc1
    s_waitcnt vmcnt(9) lgkmcnt(4)
    v_mfma_f32_32x32x16_bf16 v[144:159], v[72:75], a[52:55], v[144:159]
    ds_read_b64_tr_b16 v[88:89], v240 offset:14336
    ds_read_b64_tr_b16 v[90:91], v240 offset:15360
    v_mfma_f32_32x32x16_bf16 v[160:175], v[76:79], a[52:55], v[160:175]
    ds_read_b64_tr_b16 v[92:93], v241 offset:14336
    ds_read_b64_tr_b16 v[94:95], v241 offset:15360
    s_add_u32 s96, s35, 47104
    buffer_load_dwordx4 a[92:95], v4, s[72:75], s96 offen sc1
    s_waitcnt vmcnt(9) lgkmcnt(4)
    v_mfma_f32_32x32x16_bf16 v[144:159], v[80:83], a[56:59], v[144:159]
    ds_read_b64_tr_b16 v[64:65], v240 offset:18432
    ds_read_b64_tr_b16 v[66:67], v240 offset:19456
    v_mfma_f32_32x32x16_bf16 v[160:175], v[84:87], a[56:59], v[160:175]
    ds_read_b64_tr_b16 v[68:69], v241 offset:18432
    ds_read_b64_tr_b16 v[70:71], v241 offset:19456
    s_add_u32 s96, s35, 53248
    buffer_load_dwordx4 a[96:99], v4, s[72:75], s96 offen sc1
    s_waitcnt vmcnt(9) lgkmcnt(4)
    v_mfma_f32_32x32x16_bf16 v[144:159], v[88:91], a[60:63], v[144:159]
    ds_read_b64_tr_b16 v[72:73], v240 offset:22528
    ds_read_b64_tr_b16 v[74:75], v240 offset:23552
    v_mfma_f32_32x32x16_bf16 v[160:175], v[92:95], a[60:63], v[160:175]
    ds_read_b64_tr_b16 v[76:77], v241 offset:22528
    ds_read_b64_tr_b16 v[78:79], v241 offset:23552
    s_add_u32 s96, s35, 59392
    buffer_load_dwordx4 a[100:103], v4, s[72:75], s96 offen sc1
    s_waitcnt vmcnt(9) lgkmcnt(4)
    v_mfma_f32_32x32x16_bf16 v[144:159], v[64:67], a[64:67], v[144:159]
    ds_read_b64_tr_b16 v[80:81], v240 offset:26624
    ds_read_b64_tr_b16 v[82:83], v240 offset:27648
    v_mfma_f32_32x32x16_bf16 v[160:175], v[68:71], a[64:67], v[160:175]
    ds_read_b64_tr_b16 v[84:85], v241 offset:26624
    ds_read_b64_tr_b16 v[86:87], v241 offset:27648
    s_add_u32 s96, s35, 65536
    buffer_load_dwordx4 a[104:107], v4, s[72:75], s96 offen sc1
    s_waitcnt vmcnt(9) lgkmcnt(4)
    v_mfma_f32_32x32x16_bf16 v[144:159], v[72:75], a[68:71], v[144:159]
    ds_read_b64_tr_b16 v[88:89], v238 offset:51200
    ds_read_b64_tr_b16 v[90:91], v238 offset:52224
    v_mfma_f32_32x32x16_bf16 v[160:175], v[76:79], a[68:71], v[160:175]
    ds_read_b64_tr_b16 v[92:93], v239 offset:51200
    ds_read_b64_tr_b16 v[94:95], v239 offset:52224
    s_waitcnt vmcnt(8) lgkmcnt(4)
    v_mfma_f32_32x32x16_bf16 v[144:159], v[80:83], a[72:75], v[144:159]
    ds_read_b64_tr_b16 v[64:65], v238 offset:55296
    ds_read_b64_tr_b16 v[66:67], v238 offset:56320
    v_mfma_f32_32x32x16_bf16 v[160:175], v[84:87], a[72:75], v[160:175]
    ds_read_b64_tr_b16 v[68:69], v239 offset:55296
    ds_read_b64_tr_b16 v[70:71], v239 offset:56320
    s_waitcnt vmcnt(7) lgkmcnt(4)
    v_mfma_f32_32x32x16_bf16 v[144:159], v[88:91], a[76:79], v[144:159]
    ds_read_b64_tr_b16 v[72:73], v238 offset:59392
    ds_read_b64_tr_b16 v[74:75], v238 offset:60416
    v_mfma_f32_32x32x16_bf16 v[160:175], v[92:95], a[76:79], v[160:175]
    ds_read_b64_tr_b16 v[76:77], v239 offset:59392
    ds_read_b64_tr_b16 v[78:79], v239 offset:60416
    s_waitcnt vmcnt(6) lgkmcnt(4)
    v_mfma_f32_32x32x16_bf16 v[144:159], v[64:67], a[80:83], v[144:159]
    ds_read_b64_tr_b16 v[80:81], v238 offset:63488
    ds_read_b64_tr_b16 v[82:83], v238 offset:64512
    v_mfma_f32_32x32x16_bf16 v[160:175], v[68:71], a[80:83], v[160:175]
    ds_read_b64_tr_b16 v[84:85], v239 offset:63488
    ds_read_b64_tr_b16 v[86:87], v239 offset:64512
    s_waitcnt vmcnt(5) lgkmcnt(4)
    v_mfma_f32_32x32x16_bf16 v[144:159], v[72:75], a[84:87], v[144:159]
    v_mfma_f32_32x32x16_bf16 v[160:175], v[76:79], a[84:87], v[160:175]
    s_waitcnt vmcnt(4) lgkmcnt(0)
    v_mfma_f32_32x32x16_bf16 v[144:159], v[80:83], a[88:91], v[144:159]
    v_mfma_f32_32x32x16_bf16 v[160:175], v[84:87], a[88:91], v[160:175]
    s_waitcnt vmcnt(3)
    v_mfma_f32_32x32x16_bf16 v[144:159], v[96:99], a[92:95], v[144:159]
    v_mfma_f32_32x32x16_bf16 v[160:175], v[100:103], a[92:95], v[160:175]
    s_waitcnt vmcnt(2)
    v_mfma_f32_32x32x16_bf16 v[144:159], v[104:107], a[96:99], v[144:159]
    v_mfma_f32_32x32x16_bf16 v[160:175], v[108:111], a[96:99], v[160:175]
    s_waitcnt vmcnt(1)
    v_mfma_f32_32x32x16_bf16 v[144:159], v[112:115], a[100:103], v[144:159]
    v_mfma_f32_32x32x16_bf16 v[160:175], v[116:119], a[100:103], v[160:175]
    s_waitcnt vmcnt(0)
    v_mfma_f32_32x32x16_bf16 v[144:159], v[120:123], a[104:107], v[144:159]
    v_mfma_f32_32x32x16_bf16 v[160:175], v[124:127], a[104:107], v[160:175]
    s_lshl_b32 s85, s3, 12
    s_add_u32 s86, s85, 67584
    v_add_u32 v192, s86, v4
    s_xor_b32 s85, s85, 8192
    s_add_u32 s85, s85, 67584
    v_add_u32 v193, s85, v4
    s_nop 5
    ds_write_b128 v192, v[160:163] offset:0
    ds_write_b128 v192, v[164:167] offset:1024
    ds_write_b128 v192, v[168:171] offset:2048
    ds_write_b128 v192, v[172:175] offset:3072
    s_waitcnt lgkmcnt(0)
    s_barrier
    ds_read_b128 v[196:199], v193 offset:0
    ds_read_b128 v[200:203], v193 offset:1024
    ds_read_b128 v[204:207], v193 offset:2048
    ds_read_b128 v[208:211], v193 offset:3072
    s_waitcnt lgkmcnt(3)
    v_add_f32 v144, v144, v196
    v_add_f32 v145, v145, v197
    v_add_f32 v146, v146, v198
    v_add_f32 v147, v147, v199
    s_waitcnt lgkmcnt(2)
    v_add_f32 v148, v148, v200
    v_add_f32 v149, v149, v201
    v_add_f32 v150, v150, v202
    v_add_f32 v151, v151, v203
    s_waitcnt lgkmcnt(1)
    v_add_f32 v152, v152, v204
    v_add_f32 v153, v153, v205
    v_add_f32 v154, v154, v206
    v_add_f32 v155, v155, v207
    s_waitcnt lgkmcnt(0)
    v_add_f32 v156, v156, v208
    v_add_f32 v157, v157, v209
    v_add_f32 v158, v158, v210
    v_add_f32 v159, v159, v211
    v_add_f32 v144, v144, v24
    v_add_f32 v145, v145, v25
    v_add_f32 v146, v146, v26
    v_add_f32 v147, v147, v27
    v_add_f32 v148, v148, v28
    v_add_f32 v149, v149, v29
    v_add_f32 v150, v150, v30
    v_add_f32 v151, v151, v31
    v_add_f32 v152, v152, v32
    v_add_f32 v153, v153, v33
    v_add_f32 v154, v154, v34
    v_add_f32 v155, v155, v35
    v_add_f32 v156, v156, v36
    v_add_f32 v157, v157, v37
    v_add_f32 v158, v158, v38
    v_add_f32 v159, v159, v39
    v_cvt_pk_bf16_f32 v216, v144, v145
    v_cvt_pk_bf16_f32 v217, v146, v147
    v_cvt_pk_bf16_f32 v218, v148, v149
    v_cvt_pk_bf16_f32 v219, v150, v151
    v_cvt_pk_bf16_f32 v220, v152, v153
    v_cvt_pk_bf16_f32 v221, v154, v155
    v_cvt_pk_bf16_f32 v222, v156, v157
    v_cvt_pk_bf16_f32 v223, v158, v159
    s_nop 1
    v_permlane32_swap_b32 v216, v218
    v_permlane32_swap_b32 v217, v219
    v_permlane32_swap_b32 v220, v222
    v_permlane32_swap_b32 v221, v223
    s_lshl_b32 s85, s4, 5
    v_add_u32 v192, s85, v2
    s_lshl_b32 s86, s5, 2
    v_add_u32 v193, s86, v3
    v_and_b32 v194, 7, v192
    v_xor_b32 v195, v193, v194
    v_add_u32 v193, 2, v193
    v_xor_b32 v196, v193, v194
    v_lshlrev_b32 v192, 7, v192
    v_add_u32 v192, 83968, v192
    v_lshl_add_u32 v195, v195, 4, v192
    v_lshl_add_u32 v196, v196, 4, v192
    ds_write_b128 v195, v[216:219]
    ds_write_b128 v196, v[220:223]
    v_lshrrev_b32 v197, 3, v1
    s_lshl_b32 s85, s3, 4
    v_add_u32 v197, s85, v197
    v_and_b32 v198, 7, v1
    v_and_b32 v199, 7, v197
    v_xor_b32 v199, v198, v199
    v_lshlrev_b32 v200, 7, v197
    v_lshl_add_u32 v200, v199, 4, v200
    v_add_u32 v200, 83968, v200
    s_lshl_b32 s85, s6, 6
    v_add_u32 v197, s85, v197
    v_lshlrev_b32 v197, 10, v197
    v_lshl_add_u32 v197, v198, 4, v197
    s_lshl_b32 s85, s7, 7
    s_waitcnt lgkmcnt(0)
    s_barrier
    ds_read_b128 v[216:219], v200
    ds_read_b128 v[220:223], v200 offset:1024
    s_waitcnt lgkmcnt(1)
    buffer_store_dwordx4 v[216:219], v197, s[68:71], s85 offen nt
    s_add_u32 s85, s85, 8192
    s_waitcnt lgkmcnt(0)
    buffer_store_dwordx4 v[220:223], v197, s[68:71], s85 offen nt
L_end:
    s_endpgm

.section .rodata,"a"
.p2align 6
.amdhsa_kernel parallel_sum__sliding_local_dilated__mixer_s_mlp__prompt_kernel
  .amdhsa_next_free_vgpr 512
  .amdhsa_next_free_sgpr 102
  .amdhsa_accum_offset 256
  .amdhsa_group_segment_fixed_size 0
  .amdhsa_kernarg_size 88
  .amdhsa_user_sgpr_count 2
  .amdhsa_user_sgpr_kernarg_segment_ptr 1
  .amdhsa_system_sgpr_workgroup_id_x 1
.end_amdhsa_kernel
```
